```python
import torch

def _softmax(x, axis=-1):
    return torch.softmax(x, dim=axis)
def _gelu(x):
    return torch.nn.functional.gelu(x, approximate="tanh")
def _silu(x):
    return torch.nn.functional.silu(x)
def _sigmoid(x):
    return torch.sigmoid(x)
def _layernorm(x, axis=-1, eps=1e-5):
    m = x.mean(dim=axis, keepdim=True)
    v = x.var(dim=axis, keepdim=True, unbiased=False)
    return (x - m) / torch.sqrt(v + eps)
def _scatter_add(tgt, idx, src, axis=0):
    return tgt.clone().index_add_(axis, idx, src)
def _segment_sum(src, seg, n):
    out = torch.zeros((n,) + src.shape[1:], dtype=src.dtype)
    return out.index_add_(0, seg, src)
def _pad(x, pw):
    flat = tuple(v for pair in reversed(pw) for v in pair)
    return torch.nn.functional.pad(x, flat)

kernel_name = 'gather_scatter__cheap_equivariant_egnn__graph'

def setup_inputs():

    _w = (lambda a: (lambda t: t.to(torch.bfloat16) if t.is_floating_point() else t)(torch.as_tensor(a)))
    N, deg, D, De = 50000, 16, 64, max(16, 1)
    E = N * deg
    return {
        "h": _w((lambda *s: torch.randn(*s, dtype=torch.bfloat16) * 0.2)(N, D)),
        "pos": _w((lambda *s: torch.randn(*s, dtype=torch.bfloat16) * 0.8)(N, 3)),
        "e_attr": _w((lambda *s: torch.randn(*s, dtype=torch.bfloat16) * 0.8)(E, De)),
        "src": _w((lambda lo, hi, *s: torch.randint(lo, hi, s))(0, N, E).to(torch.int64)),
        "dst": _w((lambda lo, hi, *s: torch.randint(lo, hi, s))(0, N, E).to(torch.int64)),
        "w_e": _w(0.1 * (lambda *s: torch.randn(*s, dtype=torch.bfloat16) * 0.8)(2 * D + 1 + De, D)),
        "w_x": _w(0.1 * (lambda *s: torch.randn(*s, dtype=torch.bfloat16) * 0.2)(D, 1)),
        "w_h": _w(0.1 * (lambda *s: torch.randn(*s, dtype=torch.bfloat16) * 0.2)(2 * D, D)),
    }

def reference(h, pos, e_attr, src, dst, w_e, w_x, w_h):
    N, D = h.shape[0], h.shape[1]
    diff = pos[dst] - pos[src]
    dist2 = torch.sum(diff * diff, axis=-1, keepdims=True)
    e_in = torch.concatenate([h[dst], h[src], dist2, e_attr], axis=-1)
    m_ij = _silu(e_in @ w_e)
    coord_scale = m_ij @ w_x
    pos_new = pos + _segment_sum(diff * coord_scale, dst, N)
    m_i = _segment_sum(m_ij, dst, N)
    h_new = h + _silu(torch.concatenate([h, m_i], axis=-1) @ w_h)
    return h_new, pos_new
```

```asm
; @launch kernel=egnn_sort_kernel grid=(250,1,1) block=(512,1,1) lds=82048
; @launch kernel=egnn_main_kernel grid=(250,1,1) block=(512,1,1) lds=160512
.amdgcn_target "amdgcn-amd-amdhsa--gfx950"
.text
.globl egnn_sort_kernel
.p2align 8
.type egnn_sort_kernel,@function
egnn_sort_kernel:
    s_cmp_ge_u32 s2, 250
    s_cbranch_scc1 LS_end
LS_sort:
    s_load_dwordx4 s[8:11], s[0:1], 24
    v_lshlrev_b32 v1, 4, v0
    v_mov_b32 v4, 0
    v_mov_b32 v5, 0
    v_mov_b32 v6, 0
    v_mov_b32 v7, 0
    ds_write_b128 v1, v[4:7] offset:0
    v_lshrrev_b32 v81, 6, v0
    v_lshlrev_b32 v1, 2, v0
    s_mul_i32 s3, s2, 12800
    v_readfirstlane_b32 s6, v81
    v_add_u32 v1, s3, v1
    s_mov_b32 s36, 2048
    s_mov_b32 s37, 4096
    s_mov_b32 s38, 6144
    s_mov_b32 s39, 8192
    s_mov_b32 s40, 10240
    s_mov_b32 s41, 12288
    s_mul_i32 s3, s2, 208
    v_add_u32 v44, s3, v0
    v_mul_u32_u24 v45, 6, v44
    s_movk_i32 s7, 128
    v_cmp_gt_u32 s[42:43], s7, v0
    v_mov_b32 v47, 8160
    v_mov_b32 v49, 0
    s_mov_b32 s33, -1
    s_waitcnt lgkmcnt(0)
    s_mov_b32 s24, s10
    s_and_b32 s25, s11, 0xffff
    s_mov_b32 s26, 3200000
    s_mov_b32 s27, 0x00020000
    s_mov_b32 s20, s8
    s_and_b32 s21, s9, 0xffff
    s_mov_b32 s22, 3200000
    s_mov_b32 s23, 0x00020000
    buffer_load_dword v10, v1, s[24:27], 0 offen
    buffer_load_dword v17, v1, s[20:23], 0 offen
    buffer_load_dword v11, v1, s[24:27], s36 offen
    buffer_load_dword v18, v1, s[20:23], s36 offen
    buffer_load_dword v12, v1, s[24:27], s37 offen
    buffer_load_dword v19, v1, s[20:23], s37 offen
    buffer_load_dword v13, v1, s[24:27], s38 offen
    buffer_load_dword v20, v1, s[20:23], s38 offen
    buffer_load_dword v14, v1, s[24:27], s39 offen
    buffer_load_dword v21, v1, s[20:23], s39 offen
    buffer_load_dword v15, v1, s[24:27], s40 offen
    buffer_load_dword v22, v1, s[20:23], s40 offen
    buffer_load_dword v16, v1, s[24:27], s41 offen
    buffer_load_dword v23, v1, s[20:23], s41 offen
    s_load_dwordx2 s[4:5], s[0:1], 8
    s_load_dwordx2 s[12:13], s[0:1], 80
    s_load_dwordx4 s[52:55], s[0:1], 40
    s_load_dwordx2 s[56:57], s[0:1], 56
    s_barrier
    s_waitcnt lgkmcnt(0)
    s_mov_b32 s16, s4
    s_and_b32 s17, s5, 0xffff
    s_mov_b32 s18, 300000
    s_mov_b32 s19, 0x00020000
    s_mov_b32 s28, s12
    s_and_b32 s29, s13, 0xffff
    s_mov_b32 s30, 21688960
    s_mov_b32 s31, 0x00020000
    buffer_load_ushort v40, v45, s[16:19], 0 offen offset:0
    buffer_load_ushort v41, v45, s[16:19], 0 offen offset:2
    buffer_load_ushort v42, v45, s[16:19], 0 offen offset:4
    s_mov_b32 s14, 83887
    s_movk_i32 s15, 3200
    s_mov_b32 s7, 83200
    v_mov_b32 v3, 1
    s_waitcnt vmcnt(15)
    v_mul_u32_u24 v4, s14, v10
    v_lshrrev_b32 v4, 21, v4
    v_lshlrev_b32 v24, 2, v4
    ds_add_rtn_u32 v31, v24, v3 offset:0
    v_mul_u32_u24 v5, 25, v4
    v_sub_u32 v7, v10, v5
    v_add_u32 v8, 0, v0
    v_mad_u32_u24 v7, v7, s15, v8
    v_mad_u32_u24 v82, v17, s7, v7
    s_waitcnt vmcnt(13)
    v_mul_u32_u24 v4, s14, v11
    v_lshrrev_b32 v4, 21, v4
    v_lshlrev_b32 v25, 2, v4
    ds_add_rtn_u32 v32, v25, v3 offset:0
    v_mul_u32_u24 v5, 25, v4
    v_sub_u32 v7, v11, v5
    v_add_u32 v8, 512, v0
    v_mad_u32_u24 v7, v7, s15, v8
    v_mad_u32_u24 v83, v18, s7, v7
    s_waitcnt vmcnt(11)
    v_mul_u32_u24 v4, s14, v12
    v_lshrrev_b32 v4, 21, v4
    v_lshlrev_b32 v26, 2, v4
    ds_add_rtn_u32 v33, v26, v3 offset:0
    v_mul_u32_u24 v5, 25, v4
    v_sub_u32 v7, v12, v5
    v_add_u32 v8, 1024, v0
    v_mad_u32_u24 v7, v7, s15, v8
    v_mad_u32_u24 v84, v19, s7, v7
    s_waitcnt vmcnt(9)
    v_mul_u32_u24 v4, s14, v13
    v_lshrrev_b32 v4, 21, v4
    v_lshlrev_b32 v27, 2, v4
    ds_add_rtn_u32 v34, v27, v3 offset:0
    v_mul_u32_u24 v5, 25, v4
    v_sub_u32 v7, v13, v5
    v_add_u32 v8, 1536, v0
    v_mad_u32_u24 v7, v7, s15, v8
    v_mad_u32_u24 v85, v20, s7, v7
    s_waitcnt vmcnt(7)
    v_mul_u32_u24 v4, s14, v14
    v_lshrrev_b32 v4, 21, v4
    v_lshlrev_b32 v28, 2, v4
    ds_add_rtn_u32 v35, v28, v3 offset:0
    v_mul_u32_u24 v5, 25, v4
    v_sub_u32 v7, v14, v5
    v_add_u32 v8, 2048, v0
    v_mad_u32_u24 v7, v7, s15, v8
    v_mad_u32_u24 v86, v21, s7, v7
    s_waitcnt vmcnt(5)
    v_mul_u32_u24 v4, s14, v15
    v_lshrrev_b32 v4, 21, v4
    v_lshlrev_b32 v29, 2, v4
    ds_add_rtn_u32 v36, v29, v3 offset:0
    v_mul_u32_u24 v5, 25, v4
    v_sub_u32 v7, v15, v5
    v_add_u32 v8, 2560, v0
    v_mad_u32_u24 v7, v7, s15, v8
    v_mad_u32_u24 v87, v22, s7, v7
    s_waitcnt vmcnt(3)
    v_mul_u32_u24 v4, s14, v16
    v_lshrrev_b32 v4, 21, v4
    v_lshlrev_b32 v30, 2, v4
    v_cndmask_b32 v30, v47, v30, s[42:43]
    ds_add_rtn_u32 v37, v30, v3 offset:0
    v_mul_u32_u24 v5, 25, v4
    v_sub_u32 v7, v16, v5
    v_add_u32 v8, 3072, v0
    v_mad_u32_u24 v7, v7, s15, v8
    v_mad_u32_u24 v88, v23, s7, v7
    s_cmp_ge_u32 s6, 4
    s_cbranch_scc1 LS_nop4
    s_waitcnt vmcnt(0)
    v_lshl_or_b32 v40, v41, 16, v40
    v_lshlrev_b32 v41, 16, v42
    v_lshlrev_b32 v44, 3, v44
    v_add_u32 v44, 21288960, v44
    v_cmp_gt_u32 vcc, 208, v0
    s_mov_b64 exec, vcc
    buffer_store_dwordx2 v[40:41], v44, s[28:31], 0 offen sc1
    s_mov_b64 exec, -1
LS_nop4:
    s_cmp_lg_u32 s6, 7
    s_cbranch_scc1 LS_wi_done
    s_cmp_ge_u32 s2, 40
    s_cbranch_scc1 LS_wi_done
    s_cmp_eq_u32 s2, 23
    s_cbranch_scc1 LS_wi_done
    s_mov_b32 s33, s2
    s_mov_b32 s48, s52
    s_and_b32 s49, s53, 0xffff
    s_mov_b32 s50, 18560
    s_mov_b32 s51, 0x00020000
    s_and_b32 s58, s33, 1
    s_lshr_b32 s59, s33, 1
    s_mov_b32 s61, 8
    s_mov_b32 s62, 4
    s_mov_b32 s34, 1.0
    s_cmp_ge_u32 s33, 24
    s_cbranch_scc1 LS_wh
    s_cmp_eq_u32 s33, 22
    s_cbranch_scc1 LS_wd
    s_cmp_ge_u32 s33, 18
    s_cbranch_scc1 LS_wx
    s_lshl_b32 s60, s59, 4
    s_cmp_ge_u32 s59, 8
    s_cselect_b32 s60, 129, s60
    s_cmp_ge_u32 s59, 4
    s_cselect_b32 s34, 0xbfb8aa3b, s34
    s_branch LS_wgo
LS_wh:
    s_sub_u32 s59, s59, 12
    s_lshl_b32 s60, s59, 4
    s_cmp_ge_u32 s59, 4
    s_cselect_b32 s61, 4, 8
    s_cselect_b32 s62, 8, 4
    s_mov_b32 s48, s56
    s_and_b32 s49, s57, 0xffff
    s_mov_b32 s50, 16384
    s_mov_b32 s51, 0x00020000
LS_wgo:
    v_and_b32 v116, 31, v0
    v_bfe_u32 v117, v0, 5, 1
    v_mul_u32_u24 v117, s61, v117
    v_add_u32 v117, s60, v117
    v_lshlrev_b32 v117, 7, v117
    v_lshl_add_u32 v117, v116, 1, v117
    s_lshl_b32 s3, s58, 6
    v_add_u32 v117, s3, v117
    s_lshl_b32 s3, s62, 7
    v_add_u32 v118, s3, v117
    buffer_load_ushort v104, v117, s[48:51], 0 offen offset:0
    buffer_load_ushort v105, v117, s[48:51], 0 offen offset:128
    buffer_load_ushort v106, v117, s[48:51], 0 offen offset:256
    buffer_load_ushort v107, v117, s[48:51], 0 offen offset:384
    buffer_load_ushort v108, v118, s[48:51], 0 offen offset:0
    buffer_load_ushort v109, v118, s[48:51], 0 offen offset:128
    buffer_load_ushort v110, v118, s[48:51], 0 offen offset:256
    buffer_load_ushort v111, v118, s[48:51], 0 offen offset:384
    s_branch LS_wi_done
LS_wx:
    s_mov_b32 s48, s54
    s_and_b32 s49, s55, 0xffff
    s_mov_b32 s50, 128
    s_mov_b32 s51, 0x00020000
    s_sub_u32 s3, s33, 18
    s_lshl_b32 s3, s3, 5
    v_bfe_u32 v117, v0, 5, 1
    v_lshlrev_b32 v117, 3, v117
    v_add_u32 v117, s3, v117
    buffer_load_dwordx2 v[112:113], v117, s[48:51], 0 offen
    buffer_load_dwordx2 v[114:115], v117, s[48:51], 0 offen offset:16
    s_branch LS_wi_done
LS_wd:
    v_and_b32 v117, 31, v0
    v_lshlrev_b32 v117, 1, v117
    v_add_u32 v117, 16384, v117
    buffer_load_ushort v112, v117, s[48:51], 0 offen
    buffer_load_ushort v113, v117, s[48:51], 0 offen offset:64
LS_wi_done:
    v_lshlrev_b32 v2, 5, v0
    s_waitcnt lgkmcnt(0)
    s_barrier
    s_cmp_ge_u32 s6, 4
    s_cbranch_scc1 LS_nobkt
    ds_read_b128 v[60:63], v2 offset:0
    ds_read_b128 v[64:67], v2 offset:16
    v_lshlrev_b32 v9, 7, v0
    v_add_u32 v70, 16452, v9
    v_mov_b32 v80, 0x100000
    v_mov_b32 v79, -1
    s_movk_i32 s14, 250
    v_cmp_gt_u32 s[44:45], s14, v0
    s_waitcnt lgkmcnt(1)
    v_or3_b32 v4, v60, v61, v62
    v_lshl_or_b32 v5, v61, 4, v60
    v_add_u32 v6, v60, v61
    v_lshl_or_b32 v5, v62, 8, v5
    v_add_u32 v7, v6, v62
    v_lshl_or_b32 v5, v63, 12, v5
    v_add_u32 v8, v7, v63
    s_waitcnt lgkmcnt(0)
    v_or3_b32 v4, v4, v63, v64
    v_lshl_or_b32 v5, v64, 16, v5
    v_add_u32 v68, v8, v64
    v_or3_b32 v4, v4, v65, v66
    v_lshl_or_b32 v5, v65, 20, v5
    v_add_u32 v69, v68, v65
    v_lshl_or_b32 v5, v66, 24, v5
    v_add_u32 v78, v69, v66
    v_or_b32 v4, v4, v67
    v_lshl_or_b32 v5, v67, 28, v5
    v_add_u32 v67, v78, v67
    v_sub_u32 v61, v67, v8
    v_cmp_lt_u32 vcc, 15, v4
    v_max_u32 v61, v61, v8
    v_cmp_lt_u32 s[58:59], 31, v67
    v_cmp_lt_u32 s[46:47], 31, v61
    v_lshlrev_b32 v62, 2, v8
    v_sub_u32 v62, 32764, v62
    s_or_b64 vcc, vcc, s[46:47]
    s_and_b64 s[46:47], vcc, s[44:45]
    s_orn2_b64 vcc, vcc, s[44:45]
    v_cndmask_b32 v62, 0, v62, s[58:59]
    s_andn2_b64 s[58:59], s[58:59], vcc
    v_cndmask_b32 v70, v70, v80, vcc
    v_cndmask_b32 v5, v5, v79, vcc
    v_add_u32 v62, v62, v70
    v_lshl_add_u32 v71, v60, 2, v70
    v_lshl_add_u32 v72, v6, 2, v70
    v_lshl_add_u32 v73, v7, 2, v70
    v_lshl_add_u32 v74, v8, 2, v62
    v_lshl_add_u32 v75, v68, 2, v62
    v_lshl_add_u32 v76, v69, 2, v62
    v_lshl_add_u32 v77, v78, 2, v62
    ds_write_b32 v9, v5 offset:16448
    ds_write_b128 v2, v[70:73] offset:8256
    ds_write_b128 v2, v[74:77] offset:8272
    s_cmp_eq_u64 s[46:47], 0
    s_cbranch_scc1 LS_noflag
    v_mov_b32 v4, 0
    ds_write_b32 v4, v3 offset:8176
LS_noflag:
    s_cmp_eq_u64 s[58:59], 0
    s_cbranch_scc1 LS_noflag2
    v_mov_b32 v4, 0
    ds_write_b32 v4, v3 offset:8180
LS_noflag2:
    s_waitcnt lgkmcnt(0)
LS_nobkt:
    v_mov_b32 v4, 0
    v_mov_b32 v5, 81984
    s_barrier
    ds_read_b32 v52, v24 offset:8256
    ds_read_b32 v53, v25 offset:8256
    ds_read_b32 v54, v26 offset:8256
    ds_read_b32 v55, v27 offset:8256
    ds_read_b32 v56, v28 offset:8256
    ds_read_b32 v57, v29 offset:8256
    ds_read_b32 v58, v30 offset:8256
    ds_read_b64 v[48:49], v4 offset:8176
    v_lshlrev_b32 v1, 4, v0
    v_lshrrev_b32 v2, 3, v0
    v_mul_u32_u24 v2, 32000, v2
    v_and_b32 v6, 7, v0
    v_lshl_add_u32 v2, v6, 4, v2
    s_lshl_b32 s35, s2, 7
    s_add_u32 s36, s35, 2048000
    s_add_u32 s37, s35, 4096000
    s_add_u32 s38, s35, 6144000
    s_waitcnt lgkmcnt(7)
    v_lshl_add_u32 v6, v31, 2, v52
    v_min_u32 v6, v6, v5
    ds_write_b32 v6, v82
    s_waitcnt lgkmcnt(6)
    v_lshl_add_u32 v6, v32, 2, v53
    v_min_u32 v6, v6, v5
    ds_write_b32 v6, v83
    s_waitcnt lgkmcnt(5)
    v_lshl_add_u32 v6, v33, 2, v54
    v_min_u32 v6, v6, v5
    ds_write_b32 v6, v84
    s_waitcnt lgkmcnt(4)
    v_lshl_add_u32 v6, v34, 2, v55
    v_min_u32 v6, v6, v5
    ds_write_b32 v6, v85
    s_waitcnt lgkmcnt(3)
    v_lshl_add_u32 v6, v35, 2, v56
    v_min_u32 v6, v6, v5
    ds_write_b32 v6, v86
    s_waitcnt lgkmcnt(2)
    v_lshl_add_u32 v6, v36, 2, v57
    v_min_u32 v6, v6, v5
    ds_write_b32 v6, v87
    s_waitcnt lgkmcnt(1)
    v_lshl_add_u32 v6, v37, 2, v58
    v_min_u32 v6, v6, v5
    ds_write_b32 v6, v88
    s_waitcnt lgkmcnt(0)
    v_readfirstlane_b32 s7, v48
    v_readfirstlane_b32 s74, v49
    s_barrier
    ds_read_b128 v[60:63], v1 offset:16448
    ds_read_b128 v[64:67], v1 offset:24640
    ds_read_b128 v[68:71], v1 offset:32832
    ds_read_b128 v[72:75], v1 offset:41024
    s_movk_i32 s14, 464
    v_cmp_gt_u32 vcc, s14, v0
    s_waitcnt lgkmcnt(3)
    buffer_store_dwordx4 v[60:63], v2, s[28:31], s35 offen sc1
    s_waitcnt lgkmcnt(2)
    buffer_store_dwordx4 v[64:67], v2, s[28:31], s36 offen sc1
    s_waitcnt lgkmcnt(1)
    buffer_store_dwordx4 v[68:71], v2, s[28:31], s37 offen sc1
    s_waitcnt lgkmcnt(0)
    s_mov_b64 exec, vcc
    buffer_store_dwordx4 v[72:75], v2, s[28:31], s38 offen sc1
    s_mov_b64 exec, -1
    s_cmp_lt_i32 s33, 0
    s_cbranch_scc1 LS_wf_done
    s_waitcnt vmcnt(4)
    s_cmp_ge_u32 s33, 24
    s_cbranch_scc1 LS_wf_g
    s_cmp_eq_u32 s33, 22
    s_cbranch_scc1 LS_wf_d
    s_cmp_ge_u32 s33, 18
    s_cbranch_scc1 LS_wf_x
LS_wf_g:
    v_lshlrev_b32 v104, 16, v104
    v_mul_f32 v104, s34, v104
    v_lshlrev_b32 v105, 16, v105
    v_mul_f32 v105, s34, v105
    v_lshlrev_b32 v106, 16, v106
    v_mul_f32 v106, s34, v106
    v_lshlrev_b32 v107, 16, v107
    v_mul_f32 v107, s34, v107
    v_lshlrev_b32 v108, 16, v108
    v_mul_f32 v108, s34, v108
    v_lshlrev_b32 v109, 16, v109
    v_mul_f32 v109, s34, v109
    v_lshlrev_b32 v110, 16, v110
    v_mul_f32 v110, s34, v110
    v_lshlrev_b32 v111, 16, v111
    v_mul_f32 v111, s34, v111
    v_cvt_pk_bf16_f32 v112, v104, v105
    v_cvt_pk_bf16_f32 v113, v106, v107
    v_cvt_pk_bf16_f32 v114, v108, v109
    v_cvt_pk_bf16_f32 v115, v110, v111
    s_branch LS_wst
LS_wf_x:
    s_mov_b32 s58, 268435712
    s_mov_b32 s59, 268435712
    v_cndmask_b32 v112, 0, v112, s[58:59]
    v_lshlrev_b32 v116, 16, v112
    v_and_b32 v112, 0xffff0000, v112
    v_cvt_pk_f16_f32 v112, v116, v112
    v_cndmask_b32 v113, 0, v113, s[58:59]
    v_lshlrev_b32 v116, 16, v113
    v_and_b32 v113, 0xffff0000, v113
    v_cvt_pk_f16_f32 v113, v116, v113
    v_cndmask_b32 v114, 0, v114, s[58:59]
    v_lshlrev_b32 v116, 16, v114
    v_and_b32 v114, 0xffff0000, v114
    v_cvt_pk_f16_f32 v114, v116, v114
    v_cndmask_b32 v115, 0, v115, s[58:59]
    v_lshlrev_b32 v116, 16, v115
    v_and_b32 v115, 0xffff0000, v115
    v_cvt_pk_f16_f32 v115, v116, v115
    s_branch LS_wst
LS_wf_d:
    s_mov_b32 s3, 0xbfb8aa3b
    v_mov_b32 v114, 0
    v_mov_b32 v115, 0
    v_lshlrev_b32 v112, 16, v112
    v_mul_f32 v112, s3, v112
    v_cvt_pk_bf16_f32 v112, v112, v112
    v_lshlrev_b32 v113, 16, v113
    v_mul_f32 v113, s3, v113
    v_cvt_pk_bf16_f32 v113, v113, v113
LS_wst:
    v_and_b32 v116, 63, v0
    v_lshlrev_b32 v116, 4, v116
    s_lshl_b32 s3, s33, 10
    s_add_u32 s3, s3, 21248000
    buffer_store_dwordx4 v[112:115], v116, s[28:31], s3 offen sc1
LS_wf_done:
    s_cmp_eq_u32 s74, 0
    s_cbranch_scc1 LS_nosoft
    v_lshrrev_b32 v4, 3, v0
    v_lshlrev_b32 v4, 7, v4
    v_add_u32 v5, 32768, v1
    s_mov_b64 s[58:59], vcc
    s_mov_b32 s3, 0x11111111
    ds_read_b32 v6, v4 offset:16448
    ds_read_b128 v[100:103], v5 offset:16448
    ds_read_b32 v7, v4 offset:24640
    ds_read_b128 v[104:107], v5 offset:24640
    ds_read_b32 v8, v4 offset:32832
    ds_read_b128 v[108:111], v5 offset:32832
    ds_read_b32 v9, v4 offset:41024
    ds_read_b128 v[112:115], v5 offset:41024
    s_waitcnt lgkmcnt(0)
    v_dot8_u32_u4 v6, v6, s3, 0
    v_dot8_u32_u4 v7, v7, s3, 0
    v_dot8_u32_u4 v8, v8, s3, 0
    v_dot8_u32_u4 v9, v9, s3, 0
    s_nop 3
    s_add_u32 s14, s35, 8000000
    v_cmp_lt_u32 vcc, 31, v6
    s_mov_b64 exec, vcc
    s_cbranch_execz LS_sf0
    buffer_store_dwordx4 v[100:103], v2, s[28:31], s14 offen sc1
LS_sf0:
    s_mov_b64 exec, -1
    s_add_u32 s14, s36, 8000000
    v_cmp_lt_u32 vcc, 31, v7
    s_mov_b64 exec, vcc
    s_cbranch_execz LS_sf1
    buffer_store_dwordx4 v[104:107], v2, s[28:31], s14 offen sc1
LS_sf1:
    s_mov_b64 exec, -1
    s_add_u32 s14, s37, 8000000
    v_cmp_lt_u32 vcc, 31, v8
    s_mov_b64 exec, vcc
    s_cbranch_execz LS_sf2
    buffer_store_dwordx4 v[108:111], v2, s[28:31], s14 offen sc1
LS_sf2:
    s_mov_b64 exec, -1
    s_add_u32 s14, s38, 8000000
    v_cmp_lt_u32 vcc, 31, v9
    s_and_b64 vcc, vcc, s[58:59]
    s_mov_b64 exec, vcc
    s_cbranch_execz LS_sf3
    buffer_store_dwordx4 v[112:115], v2, s[28:31], s14 offen sc1
LS_sf3:
    s_mov_b64 exec, -1
LS_nosoft:
    s_cmp_eq_u32 s7, 0
    s_cbranch_scc1 LS_done
    ds_read_b128 v[4:7], v1 offset:0
    s_waitcnt lgkmcnt(0)
    v_add_u32 v8, v4, v5
    v_add_u32 v9, v8, v6
    v_add_u32 v90, v9, v7
    v_mov_b32 v91, v90
    s_nop 1
    v_add_u32_dpp v91, v91, v91 row_shr:1 row_mask:0xf bank_mask:0xf bound_ctrl:0
    s_nop 1
    v_add_u32_dpp v91, v91, v91 row_shr:2 row_mask:0xf bank_mask:0xf bound_ctrl:0
    s_nop 1
    v_add_u32_dpp v91, v91, v91 row_shr:4 row_mask:0xf bank_mask:0xf bound_ctrl:0
    s_nop 1
    v_add_u32_dpp v91, v91, v91 row_shr:8 row_mask:0xf bank_mask:0xf bound_ctrl:0
    s_nop 1
    v_add_u32_dpp v91, v91, v91 row_bcast:15 row_mask:0xa bank_mask:0xf
    s_nop 1
    v_add_u32_dpp v91, v91, v91 row_bcast:31 row_mask:0xc bank_mask:0xf
    s_nop 1
    v_readlane_b32 s7, v91, 63
    v_lshlrev_b32 v81, 2, v81
    v_mov_b32 v92, s7
    ds_write_b32 v81, v92 offset:8192
    s_waitcnt lgkmcnt(0)
    s_barrier
    v_mov_b32 v81, 0
    ds_read_b128 v[92:95], v81 offset:8192
    ds_read_b128 v[96:99], v81 offset:8208
    v_sub_u32 v91, v91, v90
    s_waitcnt lgkmcnt(0)
    s_cmp_gt_u32 s6, 0
    s_cselect_b32 s7, -1, 0
    v_and_b32 v92, s7, v92
    v_add_u32 v91, v91, v92
    s_cmp_gt_u32 s6, 1
    s_cselect_b32 s7, -1, 0
    v_and_b32 v93, s7, v93
    v_add_u32 v91, v91, v93
    s_cmp_gt_u32 s6, 2
    s_cselect_b32 s7, -1, 0
    v_and_b32 v94, s7, v94
    v_add_u32 v91, v91, v94
    s_cmp_gt_u32 s6, 3
    s_cselect_b32 s7, -1, 0
    v_and_b32 v95, s7, v95
    v_add_u32 v91, v91, v95
    s_cmp_gt_u32 s6, 4
    s_cselect_b32 s7, -1, 0
    v_and_b32 v96, s7, v96
    v_add_u32 v91, v91, v96
    s_cmp_gt_u32 s6, 5
    s_cselect_b32 s7, -1, 0
    v_and_b32 v97, s7, v97
    v_add_u32 v91, v91, v97
    s_cmp_gt_u32 s6, 6
    s_cselect_b32 s7, -1, 0
    v_and_b32 v98, s7, v98
    v_add_u32 v91, v91, v98
    v_mov_b32 v92, v91
    v_add_u32 v93, v91, v4
    v_add_u32 v94, v91, v8
    v_add_u32 v95, v91, v9
    ds_write_b128 v1, v[92:95] offset:8256
    v_lshl_or_b32 v96, v4, 16, v92
    v_lshl_or_b32 v97, v5, 16, v93
    v_lshl_or_b32 v98, v6, 16, v94
    v_lshl_or_b32 v99, v7, 16, v95
    s_lshl_b32 s3, s2, 13
    s_add_u32 s3, s3, 19200000
    buffer_store_dwordx4 v[96:99], v1, s[28:31], s3 offen sc1
    s_waitcnt lgkmcnt(0)
    s_barrier
    ds_read_b32 v52, v24 offset:8256
    ds_read_b32 v53, v25 offset:8256
    ds_read_b32 v54, v26 offset:8256
    ds_read_b32 v55, v27 offset:8256
    ds_read_b32 v56, v28 offset:8256
    ds_read_b32 v57, v29 offset:8256
    ds_read_b32 v58, v30 offset:8256
    s_waitcnt lgkmcnt(0)
    v_add_u32 v6, v52, v31
    v_lshlrev_b32 v6, 2, v6
    ds_write_b32 v6, v82 offset:16448
    v_add_u32 v6, v53, v32
    v_lshlrev_b32 v6, 2, v6
    ds_write_b32 v6, v83 offset:16448
    v_add_u32 v6, v54, v33
    v_lshlrev_b32 v6, 2, v6
    ds_write_b32 v6, v84 offset:16448
    v_add_u32 v6, v55, v34
    v_lshlrev_b32 v6, 2, v6
    ds_write_b32 v6, v85 offset:16448
    v_add_u32 v6, v56, v35
    v_lshlrev_b32 v6, 2, v6
    ds_write_b32 v6, v86 offset:16448
    v_add_u32 v6, v57, v36
    v_lshlrev_b32 v6, 2, v6
    ds_write_b32 v6, v87 offset:16448
    v_add_u32 v6, v58, v37
    v_lshlrev_b32 v6, 2, v6
    ds_write_b32 v6, v88 offset:16448
    s_waitcnt lgkmcnt(0)
    s_barrier
    ds_read_b128 v[92:95], v1 offset:16448
    ds_read_b128 v[100:103], v1 offset:24640
    s_mul_i32 s3, s2, 12800
    s_add_u32 s3, s3, 16000000
    s_add_u32 s7, s3, 8192
    s_movk_i32 s14, 288
    v_cmp_gt_u32 vcc, s14, v0
    s_waitcnt lgkmcnt(0)
    buffer_store_dwordx4 v[92:95], v1, s[28:31], s3 offen sc1
    s_mov_b64 exec, vcc
    s_cbranch_execz LS_ov2
    buffer_store_dwordx4 v[100:103], v1, s[28:31], s7 offen sc1
LS_ov2:
    s_mov_b64 exec, -1
LS_done:
LS_end:
    s_endpgm
.globl egnn_main_kernel
.p2align 8
.type egnn_main_kernel,@function
egnn_main_kernel:
    s_cmp_ge_u32 s2, 250
    s_cbranch_scc1 LM_end
    s_load_dwordx2 s[80:81], s[0:1], 80
    s_load_dwordx2 s[64:65], s[0:1], 0
    s_load_dwordx2 s[66:67], s[0:1], 16
    s_load_dwordx2 s[78:79], s[0:1], 64
    v_and_b32 v208, 63, v0
    v_and_b32 v209, 31, v0
    v_bfe_u32 v210, v0, 5, 1
    v_lshlrev_b32 v211, 4, v210
    v_lshlrev_b32 v212, 4, v208
    v_lshlrev_b32 v213, 2, v0
    v_lshrrev_b32 v168, 6, v0
    s_mov_b32 s50, 0
    v_readfirstlane_b32 s40, v168
    s_mov_b32 s51, -1
    s_mov_b32 s52, 0x01ffffff
    s_mov_b32 s53, 0x01ffffff
    s_mov_b32 s54, 0xffff0000
    s_mov_b32 s55, 0x007fff80
    s_mov_b32 s61, 0
    s_mov_b32 s56, 0xbf317218
    s_mov_b32 s57, 21288960
    s_mov_b32 s58, 80
    s_mov_b32 s60, 0x3c003c00
    s_lshl_b32 s62, s40, 2
    s_add_u32 s62, s62, 7680
    s_xor_b32 s63, s62, 16
    s_mul_i32 s47, s40, 10240
    s_add_u32 s47, s47, 78592
    s_mul_i32 s6, s2, 200
    s_mul_i32 s4, s40, 25
    s_add_u32 s46, s6, s4
    s_waitcnt lgkmcnt(0)
    s_mov_b32 s16, s80
    s_and_b32 s17, s81, 0xffff
    s_mov_b32 s18, 21688960
    s_mov_b32 s19, 0x00020000
    s_mul_i32 s3, s2, 32000
    s_lshl_b32 s4, s40, 12
    s_add_u32 s3, s3, s4
    s_mul_i32 s7, s40, 4160
    s_add_u32 s7, s7, 78592
    s_add_u32 m0, s7, 0
    s_add_u32 s4, s3, 0
    buffer_load_dwordx4 v212, s[16:19], s4 offen lds
    s_add_u32 m0, s7, 1040
    s_add_u32 s4, s3, 1024
    buffer_load_dwordx4 v212, s[16:19], s4 offen lds
    s_add_u32 m0, s7, 2080
    s_add_u32 s4, s3, 2048
    buffer_load_dwordx4 v212, s[16:19], s4 offen lds
    s_add_u32 m0, s7, 3120
    s_add_u32 s4, s3, 3072
    buffer_load_dwordx4 v212, s[16:19], s4 offen lds
    s_lshl_b32 s4, s40, 10
    s_add_u32 s5, s4, 21248000
    s_add_u32 m0, s4, 51968
    s_add_u32 s3, s5, 0
    buffer_load_dwordx4 v212, s[16:19], s3 offen lds
    s_add_u32 m0, s4, 60160
    s_add_u32 s3, s5, 8192
    buffer_load_dwordx4 v212, s[16:19], s3 offen lds
    s_add_u32 m0, s4, 68352
    s_add_u32 s3, s5, 16384
    buffer_load_dwordx4 v212, s[16:19], s3 offen lds
    s_mov_b32 s8, s64
    s_and_b32 s9, s65, 0xffff
    s_mov_b32 s10, 6400000
    s_mov_b32 s11, 0x00020000
    s_mov_b32 s20, s80
    s_and_b32 s21, s81, 0xffff
    s_or_b32 s21, s21, 524288
    s_mov_b32 s22, 50000
    s_mov_b32 s23, 0x00020000
    s_mov_b32 s12, s66
    s_and_b32 s13, s67, 0xffff
    s_mov_b32 s14, 25600000
    s_mov_b32 s15, 0x00020000
    s_mov_b32 s32, s78
    s_and_b32 s33, s79, 0xffff
    s_mov_b32 s34, 6700000
    s_mov_b32 s35, 0x00020000
    s_mul_i32 s4, s40, 4352
    s_add_u32 s4, s4, 43776
    v_mul_u32_u24 v168, 136, v209
    v_add_u32 v168, s4, v168
    v_lshl_add_u32 v250, v210, 3, v168
    v_add_u32 v249, 64, v168
    v_bfe_u32 v168, v208, 2, 2
    v_lshlrev_b32 v168, 2, v168
    v_add_u32 v168, v168, v210
    v_mul_u32_u24 v168, 272, v168
    v_bfe_u32 v169, v208, 4, 1
    v_lshl_add_u32 v168, v169, 5, v168
    v_and_b32 v169, 3, v208
    v_lshl_add_u32 v168, v169, 3, v168
    v_add_u32 v251, s4, v168
    v_bfe_u32 v168, v208, 2, 2
    v_lshlrev_b32 v168, 2, v168
    v_add_u32 v168, v168, v210
    v_mul_u32_u24 v168, 272, v168
    v_add_u32 v168, s4, v168
    v_add_u32 v168, 128, v168
    v_bfe_u32 v169, v208, 4, 1
    v_and_b32 v170, 3, v208
    v_cmp_eq_u32 vcc, v169, v170
    v_mov_b32 v1, 6656
    s_lshl_b32 s59, s40, 9
    v_cndmask_b32 v1, v1, v168, vcc
    s_add_u32 s59, s59, 2560
    v_add_u32 v248, 0, v211
    v_mov_b32 v253, 0x3f80
    v_mov_b32 v254, 0
    v_mul_u32_u24 v255, 0xffff, v210
    v_lshlrev_b32 v255, 16, v255
    v_lshrrev_b32 v168, 3, v208
    v_and_b32 v169, 7, v208
    v_xor_b32 v169, v169, v168
    v_lshlrev_b32 v240, 4, v169
    v_xor_b32 v241, 16, v240
    v_and_b32 v242, 1, v208
    v_lshlrev_b32 v242, 4, v242
    v_lshrrev_b32 v168, 3, v209
    v_and_b32 v169, 7, v209
    v_and_b32 v170, 1, v168
    v_xor_b32 v170, v170, v169
    v_xor_b32 v170, v170, v210
    v_lshlrev_b32 v171, 10, v168
    v_lshl_add_u32 v171, v169, 7, v171
    v_add_u32 v171, s47, v171
    v_xor_b32 v243, 0, v170
    v_lshl_add_u32 v243, v243, 4, v171
    v_xor_b32 v244, 2, v170
    v_lshl_add_u32 v244, v244, 4, v171
    v_xor_b32 v245, 4, v170
    v_lshl_add_u32 v245, v245, 4, v171
    v_xor_b32 v246, 6, v170
    v_lshl_add_u32 v246, v246, 4, v171
    v_lshl_add_u32 v247, v209, 5, v211
    v_add_u32 v247, s47, v247
    v_add_u32 v247, 4096, v247
    v_mov_b32 v176, 0
    v_mov_b32 v177, 0
    v_mov_b32 v178, 0
    v_mov_b32 v179, 0
    ds_write_b128 v212, v[176:179] offset:6656
    v_cmp_gt_u32 vcc, 32, v0
    s_and_saveexec_b64 s[48:49], vcc
    v_mul_u32_u24 v168, 80, v0
    ds_write_b128 v168, v[176:179] offset:0
    ds_write_b128 v168, v[176:179] offset:16
    ds_write_b128 v168, v[176:179] offset:32
    ds_write_b128 v168, v[176:179] offset:48
    ds_write_b128 v168, v[176:179] offset:64
    v_lshrrev_b32 v169, 4, v0
    v_lshl_add_u32 v168, v169, 5, v168
    v_bfe_u32 v169, v0, 2, 1
    v_lshl_add_u32 v168, v169, 4, v168
    v_bfe_u32 v169, v0, 3, 1
    v_lshl_add_u32 v168, v169, 3, v168
    v_and_b32 v169, 3, v0
    v_lshl_add_u32 v168, v169, 1, v168
    v_cmp_gt_u32 vcc, 31, v0
    s_and_b64 exec, exec, vcc
    ds_write_b16 v168, v253 offset:0
    s_mov_b64 exec, s[48:49]
    v_mov_b32 v253, 0x3c00
    s_lshl_b32 s44, s40, 11
    s_mov_b32 s42, 0
    s_mov_b32 s96, 0
    s_mov_b32 s64, 2
    s_mov_b32 s65, 4194304
    s_lshl_b32 s67, s40, 2
    s_bfm_b32 s66, s67, 0
    s_and_b32 s66, s66, 1145324612
    s_mov_b32 s77, 0
    s_lshl_b32 s73, s40, 8
    s_add_u32 s73, s73, 8960
    v_lshl_add_u32 v168, v208, 2, s73
    v_mov_b32 v169, 0xf7f5c880
    ds_write_b32 v168, v169
    s_add_u32 s73, s73, 2139095040
    s_add_u32 s74, s73, s65
    v_lshl_add_u32 v200, v208, 5, s44
    v_mov_b32 v192, 0
    v_mov_b32 v193, 0
    v_mov_b32 v194, 0
    v_mov_b32 v195, 0
    ds_write_b128 v200, v[192:195] offset:27392
    ds_write_b128 v200, v[192:195] offset:27408
    v_lshl_add_u32 v201, v208, 3, s42
    v_lshlrev_b32 v214, s64, v201
    v_subrev_u32 v214, s65, v214
    v_mov_b32 v202, 0
    v_lshlrev_b32 v203, 2, v208
    v_and_b32 v184, 7, v209
    v_lshrrev_b32 v185, 3, v209
    v_lshl_add_u32 v184, v184, 2, v185
    v_lshl_add_u32 v2, v184, 2, s44
    v_lshrrev_b32 v184, 3, v208
    v_lshl_add_u32 v3, v184, 4, s44
    v_bfe_u32 v184, v208, 1, 3
    v_lshrrev_b32 v185, 4, v208
    v_lshl_add_u32 v184, v184, 2, v185
    v_lshl_add_u32 v252, v184, 2, s44
    s_lshl_b32 s3, s40, 7
    s_add_u32 s3, s3, 7936
    s_sub_u32 s3, s3, s44
    v_add_u32 v184, s3, v2
    v_add_u32 v185, s46, v209
    v_lshlrev_b32 v185, 7, v185
    ds_write_b32 v184, v185
    s_sub_u32 s25, s3, 11008
    s_mov_b32 s68, -1
    s_mov_b32 s69, 0x7fffffff
    s_mov_b32 s70, -1
    s_mov_b32 s71, 0x3fffffff
    s_mov_b32 s48, 0x11111111
    v_add_u32 v169, 0, v203
    v_lshrrev_b32 v170, 3, v169
    v_mul_u32_u24 v170, 1040, v170
    v_add_u32 v170, 78592, v170
    v_and_b32 v171, 7, v169
    v_lshl_add_u32 v86, v171, 7, v170
    v_lshl_add_u32 v81, v169, 23, v86
    v_add_u32 v81, 4194308, v81
    v_add_u32 v169, 1, v203
    v_lshrrev_b32 v170, 3, v169
    v_mul_u32_u24 v170, 1040, v170
    v_add_u32 v170, 78592, v170
    v_and_b32 v171, 7, v169
    v_lshl_add_u32 v87, v171, 7, v170
    v_lshl_add_u32 v82, v169, 23, v87
    v_add_u32 v82, 4194308, v82
    v_add_u32 v169, 2, v203
    v_lshrrev_b32 v170, 3, v169
    v_mul_u32_u24 v170, 1040, v170
    v_add_u32 v170, 78592, v170
    v_and_b32 v171, 7, v169
    v_lshl_add_u32 v88, v171, 7, v170
    v_lshl_add_u32 v83, v169, 23, v88
    v_add_u32 v83, 4194308, v83
    v_add_u32 v169, 3, v203
    v_lshrrev_b32 v170, 3, v169
    v_mul_u32_u24 v170, 1040, v170
    v_add_u32 v170, 78592, v170
    v_and_b32 v171, 7, v169
    v_lshl_add_u32 v89, v171, 7, v170
    v_lshl_add_u32 v84, v169, 23, v89
    v_add_u32 v84, 4194308, v84
    s_waitcnt vmcnt(3) lgkmcnt(0)
    s_barrier
    ds_read_b32 v76, v86
    ds_read_b32 v77, v87
    ds_read_b32 v78, v88
    ds_read_b32 v79, v89
    v_add_u32 v168, s46, v209
    v_lshl_add_u32 v169, v168, 7, v211
    buffer_load_dwordx4 v[140:143], v169, s[8:11], 0 offen offset:0
    buffer_load_dwordx4 v[144:147], v169, s[8:11], 0 offen offset:32
    buffer_load_dwordx4 v[148:151], v169, s[8:11], 0 offen offset:64
    buffer_load_dwordx4 v[152:155], v169, s[8:11], 0 offen offset:96
    v_add_u32 v168, s46, v209
    buffer_load_dwordx2 v[228:229], v168, s[20:23], s57 idxen
    s_waitcnt lgkmcnt(0)
    v_cndmask_b32 v76, 0, v76, s[68:69]
    v_cndmask_b32 v77, 0, v77, s[68:69]
    v_cndmask_b32 v78, 0, v78, s[70:71]
    v_cndmask_b32 v79, 0, v79, s[70:71]
    v_dot8_u32_u4 v101, v76, s48, 0
    v_dot8_u32_u4 v102, v77, s48, 0
    v_dot8_u32_u4 v103, v78, s48, 0
    v_dot8_u32_u4 v104, v79, s48, 0
    v_dot8_u32_u4 v184, v76, s66, v81
    v_dot8_u32_u4 v185, v77, s66, v82
    v_dot8_u32_u4 v186, v78, s66, v83
    v_dot8_u32_u4 v187, v79, s66, v84
    v_bfe_u32 v96, v76, s67, 4
    v_bfe_u32 v97, v77, s67, 4
    v_bfe_u32 v98, v78, s67, 4
    v_bfe_u32 v99, v79, s67, 4
    v_max3_u32 v168, v101, v102, v103
    v_max_u32 v168, v168, v104
    v_cmp_lt_u32 vcc, 31, v168
    s_cmp_eq_u64 vcc, 0
    s_cbranch_scc1 LM_round
    v_cmp_eq_u32 vcc, 120, v168
    s_cmp_lg_u64 vcc, 0
    s_cbranch_scc1 LM_slowbase
    s_cmp_lt_u32 s40, 4
    s_cbranch_scc1 LM_round
    s_and_b32 s6, s66, 0xffff0000
    v_add_u32 v169, 0, v203
    v_lshlrev_b32 v170, 23, v169
    v_lshl_add_u32 v170, v169, 7, v170
    v_add_u32 v170, 4456448, v170
    v_dot8_u32_u4 v171, v76, s6, v170
    v_cmp_lt_u32 vcc, 31, v101
    s_nop 3
    v_cndmask_b32 v184, v184, v171, vcc
    v_add_u32 v169, 1, v203
    v_lshlrev_b32 v170, 23, v169
    v_lshl_add_u32 v170, v169, 7, v170
    v_add_u32 v170, 4456448, v170
    v_dot8_u32_u4 v171, v77, s6, v170
    v_cmp_lt_u32 vcc, 31, v102
    s_nop 3
    v_cndmask_b32 v185, v185, v171, vcc
    v_add_u32 v169, 2, v203
    v_lshlrev_b32 v170, 23, v169
    v_lshl_add_u32 v170, v169, 7, v170
    v_add_u32 v170, 4456448, v170
    v_dot8_u32_u4 v171, v78, s6, v170
    v_cmp_lt_u32 vcc, 31, v103
    s_nop 3
    v_cndmask_b32 v186, v186, v171, vcc
    v_add_u32 v169, 3, v203
    v_lshlrev_b32 v170, 23, v169
    v_lshl_add_u32 v170, v169, 7, v170
    v_add_u32 v170, 4456448, v170
    v_dot8_u32_u4 v171, v79, s6, v170
    v_cmp_lt_u32 vcc, 31, v104
    s_nop 3
    v_cndmask_b32 v187, v187, v171, vcc
    s_mov_b32 s77, 1
    s_branch LM_round
LM_slowbase:
    s_mov_b32 s64, 0
    s_mov_b32 s65, 1048576
    s_lshl_b32 s67, s40, 2
    s_bfm_b32 s66, s67, 0
    s_and_b32 s66, s66, 286331153
    s_mov_b32 s77, 2
    s_lshl_b32 s73, s40, 8
    s_add_u32 s73, s73, 8960
    v_lshl_add_u32 v168, v208, 2, s73
    v_mov_b32 v169, 0xf7f5c880
    ds_write_b32 v168, v169
    s_add_u32 s73, s73, 2139095040
    s_add_u32 s74, s73, s65
    v_lshl_add_u32 v200, v208, 5, s44
    v_mov_b32 v192, 0
    v_mov_b32 v193, 0
    v_mov_b32 v194, 0
    v_mov_b32 v195, 0
    ds_write_b128 v200, v[192:195] offset:27392
    ds_write_b128 v200, v[192:195] offset:27408
    v_lshl_add_u32 v201, v208, 3, s42
    v_lshlrev_b32 v214, s64, v201
    v_subrev_u32 v214, s65, v214
    v_mov_b32 v202, 0
    v_lshlrev_b32 v203, 2, v208
    v_and_b32 v184, 7, v209
    v_lshrrev_b32 v185, 3, v209
    v_lshl_add_u32 v184, v184, 2, v185
    v_lshl_add_u32 v2, v184, 2, s44
    v_lshrrev_b32 v184, 3, v208
    v_lshl_add_u32 v3, v184, 4, s44
    v_bfe_u32 v184, v208, 1, 3
    v_lshrrev_b32 v185, 4, v208
    v_lshl_add_u32 v184, v184, 2, v185
    v_lshl_add_u32 v252, v184, 2, s44
    s_lshl_b32 s3, s40, 7
    s_add_u32 s3, s3, 7936
    s_sub_u32 s3, s3, s44
    v_add_u32 v184, s3, v2
    v_add_u32 v185, s46, v209
    v_lshlrev_b32 v185, 7, v185
    ds_write_b32 v184, v185
    s_sub_u32 s25, s3, 11008
    s_mov_b32 s68, -1
    s_mov_b32 s69, 0x7fffffff
    s_mov_b32 s70, -1
    s_mov_b32 s71, 0x3fffffff
    s_mov_b32 s48, 0x11111111
    s_mul_i32 s3, s2, 32000
    s_lshl_b32 s4, s2, 5
    s_add_u32 s4, s4, s67
    s_add_u32 s4, s4, 19200000
    s_lshr_b32 s5, s3, 2
    s_add_u32 s7, s5, 3048576
    s_add_u32 s5, s5, 1048577
    s_movk_i32 s72, 3200
    v_add_u32 v169, 0, v203
    v_lshlrev_b32 v170, 7, v169
    v_lshlrev_b32 v171, 13, v169
    buffer_load_dword v76, v170, s[16:19], s3 offen
    buffer_load_dword v86, v171, s[16:19], s4 offen
    v_lshlrev_b32 v172, 23, v169
    v_lshl_add_u32 v81, v169, 5, v172
    v_add_u32 v81, s5, v81
    v_mad_u32_u24 v91, v169, s72, v172
    v_add_u32 v91, 5048576, v91
    v_add_u32 v169, 1, v203
    v_lshlrev_b32 v170, 7, v169
    v_lshlrev_b32 v171, 13, v169
    buffer_load_dword v77, v170, s[16:19], s3 offen
    buffer_load_dword v87, v171, s[16:19], s4 offen
    v_lshlrev_b32 v172, 23, v169
    v_lshl_add_u32 v82, v169, 5, v172
    v_add_u32 v82, s5, v82
    v_mad_u32_u24 v92, v169, s72, v172
    v_add_u32 v92, 5048576, v92
    v_add_u32 v169, 2, v203
    v_lshlrev_b32 v170, 7, v169
    v_lshlrev_b32 v171, 13, v169
    buffer_load_dword v78, v170, s[16:19], s3 offen
    buffer_load_dword v88, v171, s[16:19], s4 offen
    v_lshlrev_b32 v172, 23, v169
    v_lshl_add_u32 v83, v169, 5, v172
    v_add_u32 v83, s5, v83
    v_mad_u32_u24 v93, v169, s72, v172
    v_add_u32 v93, 5048576, v93
    v_add_u32 v169, 3, v203
    v_lshlrev_b32 v170, 7, v169
    v_lshlrev_b32 v171, 13, v169
    buffer_load_dword v79, v170, s[16:19], s3 offen
    buffer_load_dword v89, v171, s[16:19], s4 offen
    v_lshlrev_b32 v172, 23, v169
    v_lshl_add_u32 v84, v169, 5, v172
    v_add_u32 v84, s5, v84
    v_mad_u32_u24 v94, v169, s72, v172
    v_add_u32 v94, 5048576, v94
    s_waitcnt vmcnt(0)
    v_cndmask_b32 v76, 0, v76, s[68:69]
    v_cndmask_b32 v77, 0, v77, s[68:69]
    v_cndmask_b32 v78, 0, v78, s[70:71]
    v_cndmask_b32 v79, 0, v79, s[70:71]
    v_dot8_u32_u4 v101, v76, s48, 0
    v_dot8_u32_u4 v102, v77, s48, 0
    v_dot8_u32_u4 v103, v78, s48, 0
    v_dot8_u32_u4 v104, v79, s48, 0
    v_dot8_u32_u4 v184, v76, s66, v81
    v_dot8_u32_u4 v185, v77, s66, v82
    v_dot8_u32_u4 v186, v78, s66, v83
    v_dot8_u32_u4 v187, v79, s66, v84
    v_bfe_u32 v96, v76, s67, 4
    v_bfe_u32 v97, v77, s67, 4
    v_bfe_u32 v98, v78, s67, 4
    v_bfe_u32 v99, v79, s67, 4
    s_cmp_lt_u32 s40, 4
    s_cbranch_scc1 LM_sl2
    s_and_b32 s6, s66, 0xffff0000
    v_add_u32 v169, 0, v203
    v_lshlrev_b32 v170, 23, v169
    v_lshl_add_u32 v170, v169, 5, v170
    v_add_u32 v170, s7, v170
    v_dot8_u32_u4 v171, v76, s6, v170
    v_cmp_lt_u32 vcc, 31, v101
    s_nop 3
    v_cndmask_b32 v184, v184, v171, vcc
    v_add_u32 v169, 1, v203
    v_lshlrev_b32 v170, 23, v169
    v_lshl_add_u32 v170, v169, 5, v170
    v_add_u32 v170, s7, v170
    v_dot8_u32_u4 v171, v77, s6, v170
    v_cmp_lt_u32 vcc, 31, v102
    s_nop 3
    v_cndmask_b32 v185, v185, v171, vcc
    v_add_u32 v169, 2, v203
    v_lshlrev_b32 v170, 23, v169
    v_lshl_add_u32 v170, v169, 5, v170
    v_add_u32 v170, s7, v170
    v_dot8_u32_u4 v171, v78, s6, v170
    v_cmp_lt_u32 vcc, 31, v103
    s_nop 3
    v_cndmask_b32 v186, v186, v171, vcc
    v_add_u32 v169, 3, v203
    v_lshlrev_b32 v170, 23, v169
    v_lshl_add_u32 v170, v169, 5, v170
    v_add_u32 v170, s7, v170
    v_dot8_u32_u4 v171, v79, s6, v170
    v_cmp_lt_u32 vcc, 31, v104
    s_nop 3
    v_cndmask_b32 v187, v187, v171, vcc
LM_sl2:
    v_cmp_eq_u32 vcc, -1, v76
    v_and_b32 v169, 0xffff, v86
    v_add_u32 v169, v169, v91
    v_lshrrev_b32 v170, 16, v86
    v_cndmask_b32 v184, v184, v169, vcc
    v_cndmask_b32 v96, v96, v170, vcc
    v_cmp_eq_u32 vcc, -1, v77
    v_and_b32 v169, 0xffff, v87
    v_add_u32 v169, v169, v92
    v_lshrrev_b32 v170, 16, v87
    v_cndmask_b32 v185, v185, v169, vcc
    v_cndmask_b32 v97, v97, v170, vcc
    v_cmp_eq_u32 vcc, -1, v78
    v_and_b32 v169, 0xffff, v88
    v_add_u32 v169, v169, v93
    v_lshrrev_b32 v170, 16, v88
    v_cndmask_b32 v186, v186, v169, vcc
    v_cndmask_b32 v98, v98, v170, vcc
    v_cmp_eq_u32 vcc, -1, v79
    v_and_b32 v169, 0xffff, v89
    v_add_u32 v169, v169, v94
    v_lshrrev_b32 v170, 16, v89
    v_cndmask_b32 v187, v187, v169, vcc
    v_cndmask_b32 v99, v99, v170, vcc
LM_round:
    v_add_u32 v176, v96, v97
    v_add_u32 v177, v176, v98
    v_add_u32 v178, v177, v99
    v_mov_b32 v180, v178
    s_nop 1
    v_add_u32_dpp v180, v180, v180 row_shr:1 row_mask:0xf bank_mask:0xf bound_ctrl:0
    s_nop 1
    v_add_u32_dpp v180, v180, v180 row_shr:2 row_mask:0xf bank_mask:0xf bound_ctrl:0
    s_nop 1
    v_add_u32_dpp v180, v180, v180 row_shr:4 row_mask:0xf bank_mask:0xf bound_ctrl:0
    s_nop 1
    v_add_u32_dpp v180, v180, v180 row_shr:8 row_mask:0xf bank_mask:0xf bound_ctrl:0
    s_nop 1
    v_add_u32_dpp v180, v180, v180 row_bcast:15 row_mask:0xa bank_mask:0xf
    s_nop 1
    v_add_u32_dpp v180, v180, v180 row_bcast:31 row_mask:0xc bank_mask:0xf
    s_nop 1
    v_readlane_b32 s41, v180, 63
    v_sub_u32 v101, v180, v178
    v_add_u32 v102, v101, v96
    v_add_u32 v103, v101, v176
    v_add_u32 v104, v101, v177
    v_lshlrev_b32 v179, s64, v101
    v_sub_u32 v184, v184, v179
    v_lshlrev_b32 v179, s64, v102
    v_sub_u32 v185, v185, v179
    v_lshlrev_b32 v179, s64, v103
    v_sub_u32 v186, v186, v179
    v_lshlrev_b32 v179, s64, v104
    v_sub_u32 v187, v187, v179
    s_add_u32 s3, s44, 27392
    s_add_u32 s4, s44, 11008
    v_mov_b32 v177, s4
    s_sub_u32 s43, s41, s42
    s_lshl2_add_u32 s5, s43, s3
    s_cmp_lt_u32 s43, 512
    s_cselect_b32 s5, s5, s4
    v_mov_b32 v176, s5
    v_mov_b32 v178, s74
    ds_write_b32 v176, v178
    v_subrev_u32 v101, s42, v101
    v_add_u32 v96, v96, v101
    v_max_i32 v101, 0, v101
    v_min_i32 v96, 512, v96
    v_cmp_lt_i32 vcc, v101, v96
    v_lshl_add_u32 v101, v101, 2, s3
    s_nop 0
    v_cndmask_b32 v101, v177, v101, vcc
    ds_write_b32 v101, v184
    v_subrev_u32 v102, s42, v102
    v_add_u32 v97, v97, v102
    v_max_i32 v102, 0, v102
    v_min_i32 v97, 512, v97
    v_cmp_lt_i32 vcc, v102, v97
    v_lshl_add_u32 v102, v102, 2, s3
    s_nop 0
    v_cndmask_b32 v102, v177, v102, vcc
    ds_write_b32 v102, v185
    v_subrev_u32 v103, s42, v103
    v_add_u32 v98, v98, v103
    v_max_i32 v103, 0, v103
    v_min_i32 v98, 512, v98
    v_cmp_lt_i32 vcc, v103, v98
    v_lshl_add_u32 v103, v103, 2, s3
    s_nop 0
    v_cndmask_b32 v103, v177, v103, vcc
    ds_write_b32 v103, v186
    v_subrev_u32 v104, s42, v104
    v_add_u32 v99, v99, v104
    v_max_i32 v104, 0, v104
    v_min_i32 v99, 512, v99
    v_cmp_lt_i32 vcc, v104, v99
    v_lshl_add_u32 v104, v104, 2, s3
    s_nop 0
    v_cndmask_b32 v104, v177, v104, vcc
    ds_write_b32 v104, v187
    ds_read_b128 v[192:195], v200 offset:27392
    ds_read_b128 v[196:199], v200 offset:27408
    s_mov_b32 s72, 0x7fffff
    s_min_u32 s43, s43, 512
    s_add_u32 s3, s43, 31
    s_lshr_b32 s45, s3, 5
    s_lshl_b32 s4, s45, 7
    s_sub_u32 s25, s25, s4
    s_add_u32 s3, s42, 512
    s_cmp_ge_u32 s3, s41
    s_cselect_b32 s26, 1, 0
    s_cmp_ge_u32 s45, 2
    s_cselect_b32 s26, s26, 0
    s_waitcnt lgkmcnt(0)
    v_max_u32 v193, v193, v192
    v_max_u32 v194, v194, v193
    v_max_u32 v195, v195, v194
    v_max_u32 v196, v196, v195
    v_max_u32 v197, v197, v196
    v_max_u32 v198, v198, v197
    v_max_u32 v199, v199, v198
    s_nop 1
    v_mov_b32_dpp v202, v199 wave_shr:1 row_mask:0xf bank_mask:0xf
    s_nop 1
    v_max_u32_dpp v202, v202, v202 row_shr:1 row_mask:0xf bank_mask:0xf bound_ctrl:0
    s_nop 1
    v_max_u32_dpp v202, v202, v202 row_shr:2 row_mask:0xf bank_mask:0xf bound_ctrl:0
    s_nop 1
    v_max_u32_dpp v202, v202, v202 row_shr:4 row_mask:0xf bank_mask:0xf bound_ctrl:0
    s_nop 1
    v_max_u32_dpp v202, v202, v202 row_shr:8 row_mask:0xf bank_mask:0xf bound_ctrl:0
    s_nop 1
    v_max_u32_dpp v202, v202, v202 row_bcast:15 row_mask:0xa bank_mask:0xf
    s_nop 1
    v_max_u32_dpp v202, v202, v202 row_bcast:31 row_mask:0xc bank_mask:0xf
    v_max_u32 v192, v192, v202
    v_add_u32 v192, v192, v214
    v_min_u32 v192, s73, v192
    v_lshrrev_b32 v169, 23, v192
    v_and_b32 v192, s72, v192
    ds_read_b32 v168, v192 offset:0
    v_max_u32 v193, v193, v202
    v_add_u32 v193, v193, v214
    v_min_u32 v193, s73, v193
    v_lshrrev_b32 v171, 23, v193
    v_and_b32 v193, s72, v193
    ds_read_b32 v170, v193 offset:4
    v_max_u32 v194, v194, v202
    v_add_u32 v194, v194, v214
    v_min_u32 v194, s73, v194
    v_lshrrev_b32 v173, 23, v194
    v_and_b32 v194, s72, v194
    ds_read_b32 v172, v194 offset:8
    v_max_u32 v195, v195, v202
    v_add_u32 v195, v195, v214
    v_min_u32 v195, s73, v195
    v_lshrrev_b32 v175, 23, v195
    v_and_b32 v195, s72, v195
    ds_read_b32 v174, v195 offset:12
    v_max_u32 v196, v196, v202
    v_add_u32 v196, v196, v214
    v_min_u32 v196, s73, v196
    v_lshrrev_b32 v177, 23, v196
    v_and_b32 v196, s72, v196
    ds_read_b32 v176, v196 offset:16
    v_max_u32 v197, v197, v202
    v_add_u32 v197, v197, v214
    v_min_u32 v197, s73, v197
    v_lshrrev_b32 v179, 23, v197
    v_and_b32 v197, s72, v197
    ds_read_b32 v178, v197 offset:20
    v_max_u32 v198, v198, v202
    v_add_u32 v198, v198, v214
    v_min_u32 v198, s73, v198
    v_lshrrev_b32 v181, 23, v198
    v_and_b32 v198, s72, v198
    ds_read_b32 v180, v198 offset:24
    v_max_u32 v199, v199, v202
    v_add_u32 v199, v199, v214
    v_min_u32 v199, s73, v199
    v_lshrrev_b32 v183, 23, v199
    v_and_b32 v199, s72, v199
    ds_read_b32 v182, v199 offset:28
    s_cmp_eq_u32 s77, 0
    s_cbranch_scc1 LM_fast1
    s_waitcnt lgkmcnt(0)
    s_cmp_eq_u32 s77, 2
    s_cbranch_scc1 LM_slow1
    s_mul_i32 s3, s2, 32000
    s_add_u32 s3, s3, 7737856
    s_mov_b32 s4, 262080
    v_cmp_le_u32 vcc, s4, v192
    s_mov_b64 exec, vcc
    s_cbranch_execz LM_mx0
    buffer_load_dword v168, v192, s[16:19], s3 offen offset:0
LM_mx0:
    s_mov_b64 exec, -1
    v_cmp_le_u32 vcc, s4, v193
    s_mov_b64 exec, vcc
    s_cbranch_execz LM_mx1
    buffer_load_dword v170, v193, s[16:19], s3 offen offset:4
LM_mx1:
    s_mov_b64 exec, -1
    v_cmp_le_u32 vcc, s4, v194
    s_mov_b64 exec, vcc
    s_cbranch_execz LM_mx2
    buffer_load_dword v172, v194, s[16:19], s3 offen offset:8
LM_mx2:
    s_mov_b64 exec, -1
    v_cmp_le_u32 vcc, s4, v195
    s_mov_b64 exec, vcc
    s_cbranch_execz LM_mx3
    buffer_load_dword v174, v195, s[16:19], s3 offen offset:12
LM_mx3:
    s_mov_b64 exec, -1
    v_cmp_le_u32 vcc, s4, v196
    s_mov_b64 exec, vcc
    s_cbranch_execz LM_mx4
    buffer_load_dword v176, v196, s[16:19], s3 offen offset:16
LM_mx4:
    s_mov_b64 exec, -1
    v_cmp_le_u32 vcc, s4, v197
    s_mov_b64 exec, vcc
    s_cbranch_execz LM_mx5
    buffer_load_dword v178, v197, s[16:19], s3 offen offset:20
LM_mx5:
    s_mov_b64 exec, -1
    v_cmp_le_u32 vcc, s4, v198
    s_mov_b64 exec, vcc
    s_cbranch_execz LM_mx6
    buffer_load_dword v180, v198, s[16:19], s3 offen offset:24
LM_mx6:
    s_mov_b64 exec, -1
    v_cmp_le_u32 vcc, s4, v199
    s_mov_b64 exec, vcc
    s_cbranch_execz LM_mx7
    buffer_load_dword v182, v199, s[16:19], s3 offen offset:28
LM_mx7:
    s_mov_b64 exec, -1
    s_waitcnt vmcnt(0)
    s_branch LM_fast1
LM_slow1:
    s_mov_b32 s68, s16
    s_or_b32 s69, s17, 262144
    s_mov_b32 s70, 5422240
    s_mov_b32 s71, 0x00020000
    s_movk_i32 s4, 255
    v_add_u32 v192, 0, v192
    v_cmp_ne_u32 vcc, s4, v169
    s_mov_b64 exec, vcc
    s_cbranch_execz LM_sx0
    buffer_load_dword v168, v192, s[68:71], 0 idxen
LM_sx0:
    s_mov_b64 exec, -1
    v_add_u32 v193, 1, v193
    v_cmp_ne_u32 vcc, s4, v171
    s_mov_b64 exec, vcc
    s_cbranch_execz LM_sx1
    buffer_load_dword v170, v193, s[68:71], 0 idxen
LM_sx1:
    s_mov_b64 exec, -1
    v_add_u32 v194, 2, v194
    v_cmp_ne_u32 vcc, s4, v173
    s_mov_b64 exec, vcc
    s_cbranch_execz LM_sx2
    buffer_load_dword v172, v194, s[68:71], 0 idxen
LM_sx2:
    s_mov_b64 exec, -1
    v_add_u32 v195, 3, v195
    v_cmp_ne_u32 vcc, s4, v175
    s_mov_b64 exec, vcc
    s_cbranch_execz LM_sx3
    buffer_load_dword v174, v195, s[68:71], 0 idxen
LM_sx3:
    s_mov_b64 exec, -1
    v_add_u32 v196, 4, v196
    v_cmp_ne_u32 vcc, s4, v177
    s_mov_b64 exec, vcc
    s_cbranch_execz LM_sx4
    buffer_load_dword v176, v196, s[68:71], 0 idxen
LM_sx4:
    s_mov_b64 exec, -1
    v_add_u32 v197, 5, v197
    v_cmp_ne_u32 vcc, s4, v179
    s_mov_b64 exec, vcc
    s_cbranch_execz LM_sx5
    buffer_load_dword v178, v197, s[68:71], 0 idxen
LM_sx5:
    s_mov_b64 exec, -1
    v_add_u32 v198, 6, v198
    v_cmp_ne_u32 vcc, s4, v181
    s_mov_b64 exec, vcc
    s_cbranch_execz LM_sx6
    buffer_load_dword v180, v198, s[68:71], 0 idxen
LM_sx6:
    s_mov_b64 exec, -1
    v_add_u32 v199, 7, v199
    v_cmp_ne_u32 vcc, s4, v183
    s_mov_b64 exec, vcc
    s_cbranch_execz LM_sx7
    buffer_load_dword v182, v199, s[68:71], 0 idxen
LM_sx7:
    s_mov_b64 exec, -1
    s_waitcnt vmcnt(0)
LM_fast1:
    s_mov_b32 s4, 3200000
    s_mov_b32 s5, 3383112701
    s_movk_i32 s6, 3200
    s_mov_b32 s7, 83200
    s_mov_b32 s48, 1342178
    v_mov_b32 v160, 0
    s_waitcnt lgkmcnt(7)
    v_mul_hi_u32 v184, v168, s5
    v_lshrrev_b32 v184, 16, v184
    v_mul_u32_u24 v207, s7, v184
    v_sub_u32 v168, v168, v207
    v_mul_hi_u32_u24 v207, s48, v168
    v_lshl_or_b32 v184, v184, 7, v207
    v_cmp_le_u32 s[64:65], s4, v184
    v_sub_u32 v169, v169, v207
    v_mad_i32_i24 v169, v169, s6, v168
    v_addc_co_u32 v161, vcc, v160, 0, s[64:65]
    s_waitcnt lgkmcnt(6)
    v_mul_hi_u32 v185, v170, s5
    v_lshrrev_b32 v185, 16, v185
    v_mul_u32_u24 v207, s7, v185
    v_sub_u32 v170, v170, v207
    v_mul_hi_u32_u24 v207, s48, v170
    v_lshl_or_b32 v185, v185, 7, v207
    v_cmp_le_u32 s[66:67], s4, v185
    v_sub_u32 v171, v171, v207
    v_mad_i32_i24 v171, v171, s6, v170
    v_addc_co_u32 v162, vcc, v161, 0, s[66:67]
    s_waitcnt lgkmcnt(5)
    v_mul_hi_u32 v186, v172, s5
    v_lshrrev_b32 v186, 16, v186
    v_mul_u32_u24 v207, s7, v186
    v_sub_u32 v172, v172, v207
    v_mul_hi_u32_u24 v207, s48, v172
    v_lshl_or_b32 v186, v186, 7, v207
    v_cmp_le_u32 s[68:69], s4, v186
    v_sub_u32 v173, v173, v207
    v_mad_i32_i24 v173, v173, s6, v172
    v_addc_co_u32 v163, vcc, v162, 0, s[68:69]
    s_waitcnt lgkmcnt(4)
    v_mul_hi_u32 v187, v174, s5
    v_lshrrev_b32 v187, 16, v187
    v_mul_u32_u24 v207, s7, v187
    v_sub_u32 v174, v174, v207
    v_mul_hi_u32_u24 v207, s48, v174
    v_lshl_or_b32 v187, v187, 7, v207
    v_cmp_le_u32 s[70:71], s4, v187
    v_sub_u32 v175, v175, v207
    v_mad_i32_i24 v175, v175, s6, v174
    v_addc_co_u32 v164, vcc, v163, 0, s[70:71]
    s_waitcnt lgkmcnt(3)
    v_mul_hi_u32 v188, v176, s5
    v_lshrrev_b32 v188, 16, v188
    v_mul_u32_u24 v207, s7, v188
    v_sub_u32 v176, v176, v207
    v_mul_hi_u32_u24 v207, s48, v176
    v_lshl_or_b32 v188, v188, 7, v207
    v_cmp_le_u32 s[72:73], s4, v188
    v_sub_u32 v177, v177, v207
    v_mad_i32_i24 v177, v177, s6, v176
    v_addc_co_u32 v165, vcc, v164, 0, s[72:73]
    s_waitcnt lgkmcnt(2)
    v_mul_hi_u32 v189, v178, s5
    v_lshrrev_b32 v189, 16, v189
    v_mul_u32_u24 v207, s7, v189
    v_sub_u32 v178, v178, v207
    v_mul_hi_u32_u24 v207, s48, v178
    v_lshl_or_b32 v189, v189, 7, v207
    v_cmp_le_u32 s[74:75], s4, v189
    v_sub_u32 v179, v179, v207
    v_mad_i32_i24 v179, v179, s6, v178
    v_addc_co_u32 v166, vcc, v165, 0, s[74:75]
    s_waitcnt lgkmcnt(1)
    v_mul_hi_u32 v190, v180, s5
    v_lshrrev_b32 v190, 16, v190
    v_mul_u32_u24 v207, s7, v190
    v_sub_u32 v180, v180, v207
    v_mul_hi_u32_u24 v207, s48, v180
    v_lshl_or_b32 v190, v190, 7, v207
    v_cmp_le_u32 s[78:79], s4, v190
    v_sub_u32 v181, v181, v207
    v_mad_i32_i24 v181, v181, s6, v180
    v_addc_co_u32 v167, vcc, v166, 0, s[78:79]
    s_waitcnt lgkmcnt(0)
    v_mul_hi_u32 v191, v182, s5
    v_lshrrev_b32 v191, 16, v191
    v_mul_u32_u24 v207, s7, v191
    v_sub_u32 v182, v182, v207
    v_mul_hi_u32_u24 v207, s48, v182
    v_lshl_or_b32 v191, v191, 7, v207
    v_cmp_le_u32 s[80:81], s4, v191
    v_sub_u32 v183, v183, v207
    v_mad_i32_i24 v183, v183, s6, v182
    v_addc_co_u32 v206, vcc, v167, 0, s[80:81]
    v_mov_b32 v204, v206
    s_nop 1
    v_add_u32_dpp v204, v204, v204 row_shr:1 row_mask:0xf bank_mask:0xf bound_ctrl:0
    s_nop 1
    v_add_u32_dpp v204, v204, v204 row_shr:2 row_mask:0xf bank_mask:0xf bound_ctrl:0
    s_nop 1
    v_add_u32_dpp v204, v204, v204 row_shr:4 row_mask:0xf bank_mask:0xf bound_ctrl:0
    s_nop 1
    v_add_u32_dpp v204, v204, v204 row_shr:8 row_mask:0xf bank_mask:0xf bound_ctrl:0
    s_nop 1
    v_add_u32_dpp v204, v204, v204 row_bcast:15 row_mask:0xa bank_mask:0xf
    s_nop 1
    v_add_u32_dpp v204, v204, v204 row_bcast:31 row_mask:0xc bank_mask:0xf
    s_nop 1
    v_readlane_b32 s3, v204, 63
    v_sub_u32 v204, v204, v206
    s_sub_u32 s3, 512, s3
    s_lshl_b32 s3, s3, 2
    s_add_u32 s5, s44, 11008
    s_add_u32 s3, s3, s5
    v_lshl_add_u32 v205, v204, 2, s3
    v_lshlrev_b32 v206, 3, v208
    v_sub_u32 v206, v206, v204
    v_lshl_add_u32 v206, v206, 2, s5
    v_lshl_add_u32 v192, v160, 2, v205
    v_sub_u32 v207, 0, v160
    v_lshl_add_u32 v207, v207, 2, v206
    v_cndmask_b32 v192, v207, v192, s[64:65]
    ds_write2st64_b32 v192, v184, v169 offset0:0 offset1:64
    v_lshl_add_u32 v193, v161, 2, v205
    v_sub_u32 v207, 1, v161
    v_lshl_add_u32 v207, v207, 2, v206
    v_cndmask_b32 v193, v207, v193, s[66:67]
    ds_write2st64_b32 v193, v185, v171 offset0:0 offset1:64
    v_lshl_add_u32 v194, v162, 2, v205
    v_sub_u32 v207, 2, v162
    v_lshl_add_u32 v207, v207, 2, v206
    v_cndmask_b32 v194, v207, v194, s[68:69]
    ds_write2st64_b32 v194, v186, v173 offset0:0 offset1:64
    v_lshl_add_u32 v195, v163, 2, v205
    v_sub_u32 v207, 3, v163
    v_lshl_add_u32 v207, v207, 2, v206
    v_cndmask_b32 v195, v207, v195, s[70:71]
    ds_write2st64_b32 v195, v187, v175 offset0:0 offset1:64
    v_lshl_add_u32 v196, v164, 2, v205
    v_sub_u32 v207, 4, v164
    v_lshl_add_u32 v207, v207, 2, v206
    v_cndmask_b32 v196, v207, v196, s[72:73]
    ds_write2st64_b32 v196, v188, v177 offset0:0 offset1:64
    v_lshl_add_u32 v197, v165, 2, v205
    v_sub_u32 v207, 5, v165
    v_lshl_add_u32 v207, v207, 2, v206
    v_cndmask_b32 v197, v207, v197, s[74:75]
    ds_write2st64_b32 v197, v189, v179 offset0:0 offset1:64
    v_lshl_add_u32 v198, v166, 2, v205
    v_sub_u32 v207, 6, v166
    v_lshl_add_u32 v207, v207, 2, v206
    v_cndmask_b32 v198, v207, v198, s[78:79]
    ds_write2st64_b32 v198, v190, v181 offset0:0 offset1:64
    v_lshl_add_u32 v199, v167, 2, v205
    v_sub_u32 v207, 7, v167
    v_lshl_add_u32 v207, v207, 2, v206
    v_cndmask_b32 v199, v207, v199, s[80:81]
    ds_write2st64_b32 v199, v191, v183 offset0:0 offset1:64
    v_add_u32 v204, 51968, v212
    s_cmp_lg_u32 s42, 0
    s_cbranch_scc1 LM_nob3
    s_waitcnt vmcnt(5)
    s_barrier
LM_nob3:
    s_cmp_lg_u32 s45, 0
    s_cbranch_scc1 LM_g01
    s_waitcnt vmcnt(0)
    s_branch LM_nog
LM_g01:
    ds_read_b128 v[212:215], v3 offset:11008
    ds_read_b32 v238, v252 offset:27392
    ds_read_b32 v239, v2 offset:11008
    s_waitcnt lgkmcnt(0)
    v_and_or_b32 v212, v212, s55, v240
    v_and_or_b32 v213, v213, s55, v241
    v_and_or_b32 v214, v214, s55, v240
    v_and_or_b32 v215, v215, s55, v241
    v_lshl_add_u32 v238, v238, 5, v242
    v_bfe_u32 v239, v239, 7, 16
    s_add_u32 m0, s47, 0
    s_nop 0
    buffer_load_dwordx4 v212, s[8:11], 0 offen lds
    s_add_u32 m0, s47, 1024
    s_nop 0
    buffer_load_dwordx4 v213, s[8:11], 0 offen lds
    s_add_u32 m0, s47, 2048
    s_nop 0
    buffer_load_dwordx4 v214, s[8:11], 0 offen lds
    s_add_u32 m0, s47, 3072
    s_nop 0
    buffer_load_dwordx4 v215, s[8:11], 0 offen lds
    s_add_u32 m0, s47, 4096
    s_nop 0
    buffer_load_dwordx4 v238, s[12:15], 0 offen lds
    s_mov_b64 exec, s[50:51]
    buffer_load_dwordx2 v[220:221], v239, s[20:23], s57 idxen
    s_mov_b64 exec, -1
    ds_read_b128 v[212:215], v3 offset:11136
    ds_read_b32 v238, v252 offset:27520
    ds_read_b32 v239, v2 offset:11136
    s_waitcnt lgkmcnt(0)
    v_and_or_b32 v212, v212, s55, v240
    v_and_or_b32 v213, v213, s55, v241
    v_and_or_b32 v214, v214, s55, v240
    v_and_or_b32 v215, v215, s55, v241
    v_lshl_add_u32 v238, v238, 5, v242
    v_bfe_u32 v239, v239, 7, 16
    s_add_u32 m0, s47, 5120
    s_nop 0
    buffer_load_dwordx4 v212, s[8:11], 0 offen lds
    s_add_u32 m0, s47, 6144
    s_nop 0
    buffer_load_dwordx4 v213, s[8:11], 0 offen lds
    s_add_u32 m0, s47, 7168
    s_nop 0
    buffer_load_dwordx4 v214, s[8:11], 0 offen lds
    s_add_u32 m0, s47, 8192
    s_nop 0
    buffer_load_dwordx4 v215, s[8:11], 0 offen lds
    s_add_u32 m0, s47, 9216
    s_nop 0
    buffer_load_dwordx4 v238, s[12:15], 0 offen lds
    s_mov_b64 exec, s[50:51]
    buffer_load_dwordx2 v[224:225], v239, s[20:23], s57 idxen
    s_mov_b64 exec, -1
LM_nog:
    s_cmp_lg_u32 s42, 0
    s_cbranch_scc1 LM_noat2
    ds_read_b128 v[76:79], v204 offset:0
    ds_read_b128 v[80:83], v204 offset:1024
    ds_read_b128 v[84:87], v204 offset:2048
    ds_read_b128 v[88:91], v204 offset:3072
    ds_read_b128 v[92:95], v204 offset:4096
    ds_read_b128 v[96:99], v204 offset:5120
    ds_read_b128 v[100:103], v204 offset:6144
    ds_read_b128 v[104:107], v204 offset:7168
    ds_read_b128 v[4:7], v204 offset:8192
    ds_read_b128 v[8:11], v204 offset:9216
    ds_read_b128 v[12:15], v204 offset:10240
    ds_read_b128 v[16:19], v204 offset:11264
    ds_read_b128 v[20:23], v204 offset:12288
    ds_read_b128 v[24:27], v204 offset:13312
    ds_read_b128 v[28:31], v204 offset:14336
    ds_read_b128 v[32:35], v204 offset:15360
    ds_read_b128 v[36:39], v204 offset:16384
    ds_read_b128 v[40:43], v204 offset:17408
    ds_read_b128 v[60:63], v204 offset:18432
    ds_read_b128 v[64:67], v204 offset:19456
    ds_read_b128 v[68:71], v204 offset:20480
    ds_read_b128 v[72:75], v204 offset:21504
    ds_read_b64 v[156:157], v204 offset:22528
    s_waitcnt lgkmcnt(0)
    s_waitcnt vmcnt(12)
    v_mfma_f32_32x32x16_bf16 v[108:123], v[140:143], v[76:79], 0
    v_mfma_f32_32x32x16_bf16 v[108:123], v[144:147], v[84:87], v[108:123]
    v_mfma_f32_32x32x16_bf16 v[108:123], v[148:151], v[92:95], v[108:123]
    v_mfma_f32_32x32x16_bf16 v[108:123], v[152:155], v[100:103], v[108:123]
    v_mfma_f32_32x32x16_bf16 v[124:139], v[140:143], v[80:83], 0
    v_mfma_f32_32x32x16_bf16 v[124:139], v[144:147], v[88:91], v[124:139]
    v_mfma_f32_32x32x16_bf16 v[124:139], v[148:151], v[96:99], v[124:139]
    v_mfma_f32_32x32x16_bf16 v[124:139], v[152:155], v[104:107], v[124:139]
    v_lshl_add_u32 v184, v209, 4, s59
    v_mov_b32 v230, v229
    v_and_b32 v229, s54, v228
    v_lshlrev_b32 v228, 16, v228
    ds_write_b96 v184, v[228:230]
    v_mov_b32 v216, 0
    v_mov_b32 v217, 0
    v_mov_b32 v218, 0
    v_mov_b32 v219, 0
    s_mov_b32 s3, 0xbfb8aa3b
    s_nop 7
    v_mul_f32 v108, s3, v108
    v_mul_f32 v109, s3, v109
    v_mul_f32 v110, s3, v110
    v_mul_f32 v111, s3, v111
    v_mul_f32 v112, s3, v112
    v_mul_f32 v113, s3, v113
    v_mul_f32 v114, s3, v114
    v_mul_f32 v115, s3, v115
    v_mul_f32 v116, s3, v116
    v_mul_f32 v117, s3, v117
    v_mul_f32 v118, s3, v118
    v_mul_f32 v119, s3, v119
    v_mul_f32 v120, s3, v120
    v_mul_f32 v121, s3, v121
    v_mul_f32 v122, s3, v122
    v_mul_f32 v123, s3, v123
    v_mul_f32 v124, s3, v124
    v_mul_f32 v125, s3, v125
    v_mul_f32 v126, s3, v126
    v_mul_f32 v127, s3, v127
    v_mul_f32 v128, s3, v128
    v_mul_f32 v129, s3, v129
    v_mul_f32 v130, s3, v130
    v_mul_f32 v131, s3, v131
    v_mul_f32 v132, s3, v132
    v_mul_f32 v133, s3, v133
    v_mul_f32 v134, s3, v134
    v_mul_f32 v135, s3, v135
    v_mul_f32 v136, s3, v136
    v_mul_f32 v137, s3, v137
    v_mul_f32 v138, s3, v138
    v_mul_f32 v139, s3, v139
    v_cvt_pk_bf16_f32 v44, v108, v109
    v_cvt_pk_bf16_f32 v45, v110, v111
    v_cvt_pk_bf16_f32 v46, v112, v113
    v_cvt_pk_bf16_f32 v47, v114, v115
    v_cvt_pk_bf16_f32 v52, v116, v117
    v_cvt_pk_bf16_f32 v53, v118, v119
    v_cvt_pk_bf16_f32 v54, v120, v121
    v_cvt_pk_bf16_f32 v55, v122, v123
    v_bfi_b32 v55, v255, v156, v55
    v_cvt_pk_bf16_f32 v48, v124, v125
    v_cvt_pk_bf16_f32 v49, v126, v127
    v_cvt_pk_bf16_f32 v50, v128, v129
    v_cvt_pk_bf16_f32 v51, v130, v131
    v_cvt_pk_bf16_f32 v56, v132, v133
    v_cvt_pk_bf16_f32 v57, v134, v135
    v_cvt_pk_bf16_f32 v58, v136, v137
    v_cvt_pk_bf16_f32 v59, v138, v139
    v_bfi_b32 v59, v255, v157, v59
    v_mov_b32 v108, 0
    v_mov_b32 v109, 0
    v_mov_b32 v110, 0
    v_mov_b32 v111, 0
    v_mov_b32 v112, 0
    v_mov_b32 v113, 0
    v_mov_b32 v114, 0
    v_mov_b32 v115, 0
    v_mov_b32 v116, 0
    v_mov_b32 v117, 0
    v_mov_b32 v118, 0
    v_mov_b32 v119, 0
    v_mov_b32 v120, 0
    v_mov_b32 v121, 0
    v_mov_b32 v122, 0
    v_mov_b32 v123, 0
    v_mov_b32 v124, 0
    v_mov_b32 v125, 0
    v_mov_b32 v126, 0
    v_mov_b32 v127, 0
    v_mov_b32 v128, 0
    v_mov_b32 v129, 0
    v_mov_b32 v130, 0
    v_mov_b32 v131, 0
    v_mov_b32 v132, 0
    v_mov_b32 v133, 0
    v_mov_b32 v134, 0
    v_mov_b32 v135, 0
    v_mov_b32 v136, 0
    v_mov_b32 v137, 0
    v_mov_b32 v138, 0
    v_mov_b32 v139, 0
LM_noat2:
    s_cmp_eq_u32 s45, 0
    s_cbranch_scc1 LM_nt0
    ds_read_b32 v223, v2 offset:11008
    ds_read_b128 v[212:215], v3 offset:11264
    ds_read_b32 v238, v252 offset:27648
    ds_read_b32 v239, v2 offset:11264
    v_mov_b32 v184, 0
    v_mov_b32 v185, 0
    v_mov_b32 v186, 0
    v_mov_b32 v187, 0
    v_mov_b32 v188, 0
    v_mov_b32 v189, 0
    v_mov_b32 v190, 0
    v_mov_b32 v191, 0
    v_mov_b32 v192, 0
    v_mov_b32 v193, 0
    v_mov_b32 v194, 0
    v_mov_b32 v195, 0
    v_mov_b32 v196, 0
    v_mov_b32 v197, 0
    v_mov_b32 v198, 0
    v_mov_b32 v199, 0
    v_mov_b32 v176, 0
    v_mov_b32 v177, 0
    v_mov_b32 v178, 0
    v_mov_b32 v179, 0
    v_mov_b32 v180, 0
    v_mov_b32 v181, 0
    v_mov_b32 v182, 0
    v_mov_b32 v183, 0
    v_mov_b32 v200, 0
    v_mov_b32 v201, 0
    v_mov_b32 v202, 0
    v_mov_b32 v203, 0
    v_mov_b32 v235, 0
    v_mov_b32 v236, 0
    v_mov_b32 v237, 0
    s_waitcnt lgkmcnt(0)
    v_and_b32 v227, 31, v223
    v_mad_u32_u24 v223, v227, s58, v248
    v_lshl_add_u32 v228, v227, 4, s59
    v_lshl_add_u32 v231, v227, 1, v249
    v_and_or_b32 v212, v212, s55, v240
    v_and_or_b32 v213, v213, s55, v241
    v_and_or_b32 v214, v214, s55, v240
    v_and_or_b32 v215, v215, s55, v241
    v_lshl_add_u32 v238, v238, 5, v242
    v_bfe_u32 v239, v239, 7, 16
    s_waitcnt vmcnt(6)
    ds_read_b128 v[140:143], v243 offset:0
    ds_read_b128 v[144:147], v244 offset:0
    ds_read_b128 v[148:151], v245 offset:0
    ds_read_b128 v[152:155], v246 offset:0
    ds_read_b128 v[156:159], v247 offset:0
    ds_read_b128 v[160:163], v223
    ds_read_b128 v[164:167], v223 offset:32
    ds_read_b96 v[228:230], v228
    v_lshlrev_b32 v222, 16, v220
    v_and_b32 v220, s54, v220
    s_waitcnt lgkmcnt(0)
    v_sub_f32 v228, v228, v222
    v_sub_f32 v229, v229, v220
    v_sub_f32 v230, v230, v221
    v_cvt_pk_bf16_f32 v228, v228, v229
    v_cvt_pk_bf16_f32 v230, v230, v230
    v_lshlrev_b32 v232, 16, v228
    v_and_b32 v233, s54, v228
    v_lshlrev_b32 v234, 16, v230
    v_mul_f32 v229, v232, v232
    v_fma_f32 v229, v233, v233, v229
    v_fma_f32 v229, v234, v234, v229
    v_cvt_pk_bf16_f32 v229, v229, v229
    v_bfi_b32 v167, v255, v229, v167
    s_add_u32 m0, s47, 0
    s_nop 0
    buffer_load_dwordx4 v212, s[8:11], 0 offen lds
    s_add_u32 m0, s47, 1024
    s_nop 0
    buffer_load_dwordx4 v213, s[8:11], 0 offen lds
    s_add_u32 m0, s47, 2048
    s_nop 0
    buffer_load_dwordx4 v214, s[8:11], 0 offen lds
    s_add_u32 m0, s47, 3072
    s_nop 0
    buffer_load_dwordx4 v215, s[8:11], 0 offen lds
    s_add_u32 m0, s47, 4096
    s_nop 0
    buffer_load_dwordx4 v238, s[12:15], 0 offen lds
    s_mov_b64 exec, s[50:51]
    buffer_load_dwordx2 v[220:221], v239, s[20:23], s57 idxen
    s_mov_b64 exec, -1
    v_mfma_f32_32x32x16_bf16 v[76:91], v[4:7], v[140:143], 0
    v_mfma_f32_32x32x16_bf16 v[76:91], v[12:15], v[144:147], v[76:91]
    v_mfma_f32_32x32x16_bf16 v[76:91], v[20:23], v[148:151], v[76:91]
    v_mfma_f32_32x32x16_bf16 v[76:91], v[28:31], v[152:155], v[76:91]
    v_mfma_f32_32x32x16_bf16 v[76:91], v[36:39], v[156:159], v[76:91]
    v_mfma_f32_32x32x16_bf16 v[76:91], v[44:47], v[160:163], v[76:91]
    v_mfma_f32_32x32x16_bf16 v[76:91], v[52:55], v[164:167], v[76:91]
    s_cmp_lg_u32 s42, 0
    s_cbranch_scc1 LM_nob4
    v_lshl_add_u32 v204, v210, 5, v249
    s_barrier
    ds_write_b64 v204, v[184:185] offset:0
    ds_write_b64 v204, v[184:185] offset:8
    ds_write_b64 v204, v[184:185] offset:16
    ds_write_b64 v204, v[184:185] offset:24
LM_nob4:
    s_nop 15
LM_loop:
    ds_read_b32 v223, v2 offset:11136
    v_mfma_f32_32x32x16_bf16 v[92:107], v[8:11], v[140:143], 0
    v_cvt_pk_f16_f32 v168, v76, v77
    v_cvt_pk_f16_f32 v169, v78, v79
    v_mov_b32 v212, s45
    v_cvt_pk_f16_f32 v170, v80, v81
    v_mov_b32 v213, s62
    v_cvt_pk_f16_f32 v171, v82, v83
    s_waitcnt lgkmcnt(1)
    v_mfma_f32_32x32x16_f16 v[124:139], v[184:187], v[192:195], v[124:139]
    v_mov_b32 v214, s63
    v_exp_f16 v204, v168
    ds_write_b32 v213, v212
    ds_read_b32 v215, v214
    v_exp_f16 v205, v169
    v_exp_f16 v206, v170
    v_mfma_f32_32x32x16_bf16 v[92:107], v[16:19], v[144:147], v[92:107]
    v_exp_f16 v207, v171
    v_exp_f16_sdwa v204, v168 dst_sel:WORD_1 dst_unused:UNUSED_PRESERVE src0_sel:WORD_1
    v_exp_f16_sdwa v205, v169 dst_sel:WORD_1 dst_unused:UNUSED_PRESERVE src0_sel:WORD_1
    v_mfma_f32_32x32x16_f16 v[124:139], v[188:191], v[196:199], v[124:139]
    v_exp_f16_sdwa v206, v170 dst_sel:WORD_1 dst_unused:UNUSED_PRESERVE src0_sel:WORD_1
    v_exp_f16_sdwa v207, v171 dst_sel:WORD_1 dst_unused:UNUSED_PRESERVE src0_sel:WORD_1
    v_pk_add_f16 v204, v204, s60
    v_mfma_f32_32x32x16_bf16 v[92:107], v[24:27], v[148:151], v[92:107]
    v_pk_add_f16 v205, v205, s60
    v_pk_add_f16 v206, v206, s60
    v_pk_add_f16 v207, v207, s60
    v_mfma_f32_16x16x32_f16 v[200:203], v[68:71], v[176:179], v[200:203]
    v_rcp_f16_sdwa v204, v204 dst_sel:WORD_0 dst_unused:UNUSED_PRESERVE src0_sel:WORD_0
    v_rcp_f16_sdwa v205, v205 dst_sel:WORD_0 dst_unused:UNUSED_PRESERVE src0_sel:WORD_0
    v_rcp_f16_sdwa v206, v206 dst_sel:WORD_0 dst_unused:UNUSED_PRESERVE src0_sel:WORD_0
    v_mfma_f32_32x32x16_bf16 v[92:107], v[32:35], v[152:155], v[92:107]
    v_rcp_f16_sdwa v207, v207 dst_sel:WORD_0 dst_unused:UNUSED_PRESERVE src0_sel:WORD_0
    v_rcp_f16_sdwa v204, v204 dst_sel:WORD_1 dst_unused:UNUSED_PRESERVE src0_sel:WORD_1
    v_mfma_f32_16x16x32_f16 v[200:203], v[72:75], v[180:183], v[200:203]
    v_rcp_f16_sdwa v205, v205 dst_sel:WORD_1 dst_unused:UNUSED_PRESERVE src0_sel:WORD_1
    v_rcp_f16_sdwa v206, v206 dst_sel:WORD_1 dst_unused:UNUSED_PRESERVE src0_sel:WORD_1
    v_rcp_f16_sdwa v207, v207 dst_sel:WORD_1 dst_unused:UNUSED_PRESERVE src0_sel:WORD_1
    v_mfma_f32_32x32x16_bf16 v[92:107], v[40:43], v[156:159], v[92:107]
    v_pk_mul_f16 v168, v168, v204
    v_pk_mul_f16 v169, v169, v205
    s_waitcnt lgkmcnt(0)
    v_readfirstlane_b32 s76, v215
    v_pk_mul_f16 v170, v170, v206
    v_pk_mul_f16 v171, v171, v207
    ds_write_b64 v250, v[168:169] offset:0
    ds_write_b64 v250, v[170:171] offset:16
    v_mfma_f32_32x32x16_bf16 v[92:107], v[48:51], v[160:163], v[92:107]
    s_setprio 0
    s_cmp_gt_u32 s45, s76
    s_cbranch_scc0 LM_pg0
    s_setprio 1
    LM_pg0:
    v_cvt_pk_f16_f32 v172, v84, v85
    v_cvt_pk_f16_f32 v173, v86, v87
    s_waitcnt vmcnt(6)
    ds_read_b128 v[140:143], v243 offset:5120
    ds_read_b128 v[144:147], v244 offset:5120
    ds_read_b128 v[148:151], v245 offset:5120
    ds_read_b128 v[152:155], v246 offset:5120
    ds_read_b128 v[156:159], v247 offset:5120
    v_cvt_pk_f16_f32 v174, v88, v89
    v_mul_f32 v200, s56, v200
    v_cvt_pk_f16_f32 v175, v90, v91
    v_cvt_pk_bf16_f32 v200, v200, v200
    v_and_b32 v200, s54, v200
    v_exp_f16 v208, v172
    v_mfma_f32_32x32x16_bf16 v[92:107], v[56:59], v[164:167], v[92:107]
    v_exp_f16 v209, v173
    v_mul_f32 v235, v235, v200
    v_exp_f16 v210, v174
    v_mul_f32 v236, v236, v200
    v_mul_f32 v237, v237, v200
    v_exp_f16 v211, v175
    v_cvt_pk_f16_f32 v202, v235, v236
    v_exp_f16_sdwa v208, v172 dst_sel:WORD_1 dst_unused:UNUSED_PRESERVE src0_sel:WORD_1
    v_cvt_pk_f16_f32 v203, v237, v237
    s_mov_b64 exec, s[50:51]
    ds_write_b64 v249, v[202:203] offset:64
    s_mov_b64 exec, -1
    ds_read_b64_tr_b16 v[184:185], v1 offset:0
    ds_read_b64_tr_b16 v[186:187], v1 offset:136
    ds_read_b64_tr_b16 v[188:189], v1 offset:544
    ds_read_b64_tr_b16 v[190:191], v1 offset:680
    v_exp_f16_sdwa v209, v173 dst_sel:WORD_1 dst_unused:UNUSED_PRESERVE src0_sel:WORD_1
    s_waitcnt lgkmcnt(14)
    v_and_b32 v227, 31, v223
    v_exp_f16_sdwa v210, v174 dst_sel:WORD_1 dst_unused:UNUSED_PRESERVE src0_sel:WORD_1
    v_mad_u32_u24 v223, v227, s58, v248
    v_lshl_add_u32 v228, v227, 4, s59
    v_exp_f16_sdwa v211, v175 dst_sel:WORD_1 dst_unused:UNUSED_PRESERVE src0_sel:WORD_1
    ds_read_b128 v[160:163], v223
    ds_read_b128 v[164:167], v223 offset:32
    ds_read_b96 v[228:230], v228
    v_pk_add_f16 v208, v208, s60
    v_pk_add_f16 v209, v209, s60
    v_lshlrev_b32 v226, 16, v224
    v_pk_add_f16 v210, v210, s60
    v_and_b32 v224, s54, v224
    v_pk_add_f16 v211, v211, s60
    v_rcp_f16_sdwa v208, v208 dst_sel:WORD_0 dst_unused:UNUSED_PRESERVE src0_sel:WORD_0
    v_rcp_f16_sdwa v209, v209 dst_sel:WORD_0 dst_unused:UNUSED_PRESERVE src0_sel:WORD_0
    v_rcp_f16_sdwa v210, v210 dst_sel:WORD_0 dst_unused:UNUSED_PRESERVE src0_sel:WORD_0
    ds_write_b16 v231, v253
    v_rcp_f16_sdwa v211, v211 dst_sel:WORD_0 dst_unused:UNUSED_PRESERVE src0_sel:WORD_0
    v_rcp_f16_sdwa v208, v208 dst_sel:WORD_1 dst_unused:UNUSED_PRESERVE src0_sel:WORD_1
    v_rcp_f16_sdwa v209, v209 dst_sel:WORD_1 dst_unused:UNUSED_PRESERVE src0_sel:WORD_1
    s_waitcnt lgkmcnt(4)
    v_mfma_f32_16x16x32_f16 v[216:219], v[184:187], v[192:195], v[216:219]
    v_rcp_f16_sdwa v210, v210 dst_sel:WORD_1 dst_unused:UNUSED_PRESERVE src0_sel:WORD_1
    v_rcp_f16_sdwa v211, v211 dst_sel:WORD_1 dst_unused:UNUSED_PRESERVE src0_sel:WORD_1
    v_pk_mul_f16 v172, v172, v208
    v_mfma_f32_16x16x32_f16 v[216:219], v[188:191], v[196:199], v[216:219]
    v_pk_mul_f16 v173, v173, v209
    v_pk_mul_f16 v174, v174, v210
    v_pk_mul_f16 v175, v175, v211
    ds_write_b64 v250, v[172:173] offset:32
    ds_write_b64 v250, v[174:175] offset:48
    ds_read_b64_tr_b16 v[184:185], v251 offset:0
    ds_read_b64_tr_b16 v[186:187], v251 offset:136
    ds_read_b64_tr_b16 v[188:189], v251 offset:544
    ds_read_b64_tr_b16 v[190:191], v251 offset:680
    ds_read_b64_tr_b16 v[192:193], v251 offset:64
    ds_read_b64_tr_b16 v[194:195], v251 offset:200
    ds_read_b64_tr_b16 v[196:197], v251 offset:608
    ds_read_b64_tr_b16 v[198:199], v251 offset:744
    ds_write_b16 v231, v254
    s_cmp_eq_u32 s45, s26
    s_cbranch_scc1 LM_tail0
    s_cmp_eq_u32 s45, 2
    s_cselect_b32 s24, s25, 128
    v_add_u32 v3, s24, v3
    ds_read_b128 v[212:215], v3 offset:11264
    ds_read_b32 v238, v252 offset:27776
    ds_read_b32 v239, v2 offset:11392
    v_cvt_pk_f16_f32 v176, v92, v93
    v_cvt_pk_f16_f32 v177, v94, v95
    s_waitcnt lgkmcnt(15)
    v_sub_f32 v228, v228, v226
    v_cvt_pk_f16_f32 v178, v96, v97
    v_sub_f32 v229, v229, v224
    v_cvt_pk_f16_f32 v179, v98, v99
    v_sub_f32 v230, v230, v225
    v_mfma_f32_32x32x16_bf16 v[76:91], v[4:7], v[140:143], 0
    v_exp_f16 v204, v176
    v_cvt_pk_bf16_f32 v228, v228, v229
    v_exp_f16 v205, v177
    v_cvt_pk_bf16_f32 v230, v230, v230
    v_exp_f16 v206, v178
    v_lshlrev_b32 v235, 16, v228
    s_waitcnt lgkmcnt(4)
    v_mfma_f32_32x32x16_f16 v[108:123], v[184:187], v[192:195], v[108:123]
    v_exp_f16 v207, v179
    v_and_b32 v236, s54, v228
    v_exp_f16_sdwa v204, v176 dst_sel:WORD_1 dst_unused:UNUSED_PRESERVE src0_sel:WORD_1
    v_lshlrev_b32 v237, 16, v230
    v_exp_f16_sdwa v205, v177 dst_sel:WORD_1 dst_unused:UNUSED_PRESERVE src0_sel:WORD_1
    v_mfma_f32_32x32x16_bf16 v[76:91], v[12:15], v[144:147], v[76:91]
    v_exp_f16_sdwa v206, v178 dst_sel:WORD_1 dst_unused:UNUSED_PRESERVE src0_sel:WORD_1
    v_mul_f32 v229, v235, v235
    v_fma_f32 v229, v236, v236, v229
    v_exp_f16_sdwa v207, v179 dst_sel:WORD_1 dst_unused:UNUSED_PRESERVE src0_sel:WORD_1
    v_fma_f32 v229, v237, v237, v229
    v_pk_add_f16 v204, v204, s60
    v_mfma_f32_32x32x16_f16 v[108:123], v[188:191], v[196:199], v[108:123]
    v_pk_add_f16 v205, v205, s60
    v_cvt_pk_bf16_f32 v229, v229, v229
    v_bfi_b32 v167, v255, v229, v167
    v_pk_add_f16 v206, v206, s60
    v_lshl_add_u32 v231, v227, 1, v249
    v_pk_add_f16 v207, v207, s60
    v_mfma_f32_32x32x16_bf16 v[76:91], v[20:23], v[148:151], v[76:91]
    v_rcp_f16_sdwa v204, v204 dst_sel:WORD_0 dst_unused:UNUSED_PRESERVE src0_sel:WORD_0
    s_waitcnt lgkmcnt(0)
    v_and_or_b32 v212, v212, s55, v240
    v_rcp_f16_sdwa v205, v205 dst_sel:WORD_0 dst_unused:UNUSED_PRESERVE src0_sel:WORD_0
    v_mfma_f32_16x16x32_f16 v[200:203], v[60:63], v[168:171], 0
    v_and_or_b32 v213, v213, s55, v241
    v_rcp_f16_sdwa v206, v206 dst_sel:WORD_0 dst_unused:UNUSED_PRESERVE src0_sel:WORD_0
    v_and_or_b32 v214, v214, s55, v240
    v_rcp_f16_sdwa v207, v207 dst_sel:WORD_0 dst_unused:UNUSED_PRESERVE src0_sel:WORD_0
    v_and_or_b32 v215, v215, s55, v241
    v_rcp_f16_sdwa v204, v204 dst_sel:WORD_1 dst_unused:UNUSED_PRESERVE src0_sel:WORD_1
    v_mfma_f32_32x32x16_bf16 v[76:91], v[28:31], v[152:155], v[76:91]
    v_lshl_add_u32 v238, v238, 5, v242
    v_rcp_f16_sdwa v205, v205 dst_sel:WORD_1 dst_unused:UNUSED_PRESERVE src0_sel:WORD_1
    v_bfe_u32 v239, v239, 7, 16
    v_rcp_f16_sdwa v206, v206 dst_sel:WORD_1 dst_unused:UNUSED_PRESERVE src0_sel:WORD_1
    v_rcp_f16_sdwa v207, v207 dst_sel:WORD_1 dst_unused:UNUSED_PRESERVE src0_sel:WORD_1
    v_mfma_f32_16x16x32_f16 v[200:203], v[64:67], v[172:175], v[200:203]
    v_pk_mul_f16 v176, v176, v204
    s_cmp_lt_u32 s45, 4
    s_cselect_b32 s27, 0, 6400000
    s_cselect_b32 s14, 0, s14
    s_cselect_b32 s22, 0, s22
    s_cmp_eq_u32 s45, 2
    s_cselect_b32 s10, 6400000, s27
    v_pk_mul_f16 v177, v177, v205
    v_mfma_f32_32x32x16_bf16 v[76:91], v[36:39], v[156:159], v[76:91]
    v_pk_mul_f16 v178, v178, v206
    v_pk_mul_f16 v179, v179, v207
    ds_write_b64 v250, v[176:177] offset:0
    ds_write_b64 v250, v[178:179] offset:16
    v_cvt_pk_f16_f32 v180, v100, v101
    v_cvt_pk_f16_f32 v181, v102, v103
    v_cvt_pk_f16_f32 v182, v104, v105
    v_mfma_f32_32x32x16_bf16 v[76:91], v[44:47], v[160:163], v[76:91]
    s_add_u32 m0, s47, 5120
    v_cvt_pk_f16_f32 v183, v106, v107
    buffer_load_dwordx4 v212, s[8:11], 0 offen lds
    v_exp_f16 v208, v180
    v_exp_f16 v209, v181
    s_add_u32 m0, s47, 6144
    v_exp_f16 v210, v182
    buffer_load_dwordx4 v213, s[8:11], 0 offen lds
    v_exp_f16 v211, v183
    v_mfma_f32_32x32x16_bf16 v[76:91], v[52:55], v[164:167], v[76:91]
    v_exp_f16_sdwa v208, v180 dst_sel:WORD_1 dst_unused:UNUSED_PRESERVE src0_sel:WORD_1
    s_add_u32 m0, s47, 7168
    v_exp_f16_sdwa v209, v181 dst_sel:WORD_1 dst_unused:UNUSED_PRESERVE src0_sel:WORD_1
    buffer_load_dwordx4 v214, s[8:11], 0 offen lds
    v_exp_f16_sdwa v210, v182 dst_sel:WORD_1 dst_unused:UNUSED_PRESERVE src0_sel:WORD_1
    s_add_u32 m0, s47, 8192
    v_exp_f16_sdwa v211, v183 dst_sel:WORD_1 dst_unused:UNUSED_PRESERVE src0_sel:WORD_1
    buffer_load_dwordx4 v215, s[8:11], 0 offen lds
    v_pk_add_f16 v208, v208, s60
    s_add_u32 m0, s47, 9216
    v_pk_add_f16 v209, v209, s60
    buffer_load_dwordx4 v238, s[12:15], 0 offen lds
    v_pk_add_f16 v210, v210, s60
    v_pk_add_f16 v211, v211, s60
    s_mov_b64 exec, s[50:51]
    buffer_load_dwordx2 v[224:225], v239, s[20:23], s57 idxen
    s_mov_b64 exec, -1
    v_rcp_f16_sdwa v208, v208 dst_sel:WORD_0 dst_unused:UNUSED_PRESERVE src0_sel:WORD_0
    v_rcp_f16_sdwa v209, v209 dst_sel:WORD_0 dst_unused:UNUSED_PRESERVE src0_sel:WORD_0
    v_rcp_f16_sdwa v210, v210 dst_sel:WORD_0 dst_unused:UNUSED_PRESERVE src0_sel:WORD_0
    v_rcp_f16_sdwa v211, v211 dst_sel:WORD_0 dst_unused:UNUSED_PRESERVE src0_sel:WORD_0
    v_rcp_f16_sdwa v208, v208 dst_sel:WORD_1 dst_unused:UNUSED_PRESERVE src0_sel:WORD_1
    v_rcp_f16_sdwa v209, v209 dst_sel:WORD_1 dst_unused:UNUSED_PRESERVE src0_sel:WORD_1
    v_rcp_f16_sdwa v210, v210 dst_sel:WORD_1 dst_unused:UNUSED_PRESERVE src0_sel:WORD_1
    v_rcp_f16_sdwa v211, v211 dst_sel:WORD_1 dst_unused:UNUSED_PRESERVE src0_sel:WORD_1
    v_pk_mul_f16 v180, v180, v208
    v_pk_mul_f16 v181, v181, v209
    v_pk_mul_f16 v182, v182, v210
    v_pk_mul_f16 v183, v183, v211
    ds_write_b64 v250, v[180:181] offset:32
    ds_write_b64 v250, v[182:183] offset:48
    ds_read_b64_tr_b16 v[184:185], v251 offset:0
    ds_read_b64_tr_b16 v[186:187], v251 offset:136
    ds_read_b64_tr_b16 v[188:189], v251 offset:544
    ds_read_b64_tr_b16 v[190:191], v251 offset:680
    s_sub_u32 s45, s45, 1
    s_cmp_eq_u32 s45, 0
    s_cbranch_scc1 LM_drain0
    ds_read_b32 v223, v2 offset:11264
    v_mfma_f32_32x32x16_bf16 v[92:107], v[8:11], v[140:143], 0
    v_cvt_pk_f16_f32 v168, v76, v77
    v_cvt_pk_f16_f32 v169, v78, v79
    v_mov_b32 v212, s45
    v_cvt_pk_f16_f32 v170, v80, v81
    v_mov_b32 v213, s62
    v_cvt_pk_f16_f32 v171, v82, v83
    s_waitcnt lgkmcnt(1)
    v_mfma_f32_32x32x16_f16 v[124:139], v[184:187], v[192:195], v[124:139]
    v_mov_b32 v214, s63
    v_exp_f16 v204, v168
    ds_write_b32 v213, v212
    ds_read_b32 v215, v214
    v_exp_f16 v205, v169
    v_exp_f16 v206, v170
    v_mfma_f32_32x32x16_bf16 v[92:107], v[16:19], v[144:147], v[92:107]
    v_exp_f16 v207, v171
    v_exp_f16_sdwa v204, v168 dst_sel:WORD_1 dst_unused:UNUSED_PRESERVE src0_sel:WORD_1
    v_exp_f16_sdwa v205, v169 dst_sel:WORD_1 dst_unused:UNUSED_PRESERVE src0_sel:WORD_1
    v_mfma_f32_32x32x16_f16 v[124:139], v[188:191], v[196:199], v[124:139]
    v_exp_f16_sdwa v206, v170 dst_sel:WORD_1 dst_unused:UNUSED_PRESERVE src0_sel:WORD_1
    v_exp_f16_sdwa v207, v171 dst_sel:WORD_1 dst_unused:UNUSED_PRESERVE src0_sel:WORD_1
    v_pk_add_f16 v204, v204, s60
    v_mfma_f32_32x32x16_bf16 v[92:107], v[24:27], v[148:151], v[92:107]
    v_pk_add_f16 v205, v205, s60
    v_pk_add_f16 v206, v206, s60
    v_pk_add_f16 v207, v207, s60
    v_mfma_f32_16x16x32_f16 v[200:203], v[68:71], v[176:179], v[200:203]
    v_rcp_f16_sdwa v204, v204 dst_sel:WORD_0 dst_unused:UNUSED_PRESERVE src0_sel:WORD_0
    v_rcp_f16_sdwa v205, v205 dst_sel:WORD_0 dst_unused:UNUSED_PRESERVE src0_sel:WORD_0
    v_rcp_f16_sdwa v206, v206 dst_sel:WORD_0 dst_unused:UNUSED_PRESERVE src0_sel:WORD_0
    v_mfma_f32_32x32x16_bf16 v[92:107], v[32:35], v[152:155], v[92:107]
    v_rcp_f16_sdwa v207, v207 dst_sel:WORD_0 dst_unused:UNUSED_PRESERVE src0_sel:WORD_0
    v_rcp_f16_sdwa v204, v204 dst_sel:WORD_1 dst_unused:UNUSED_PRESERVE src0_sel:WORD_1
    v_mfma_f32_16x16x32_f16 v[200:203], v[72:75], v[180:183], v[200:203]
    v_rcp_f16_sdwa v205, v205 dst_sel:WORD_1 dst_unused:UNUSED_PRESERVE src0_sel:WORD_1
    v_rcp_f16_sdwa v206, v206 dst_sel:WORD_1 dst_unused:UNUSED_PRESERVE src0_sel:WORD_1
    v_rcp_f16_sdwa v207, v207 dst_sel:WORD_1 dst_unused:UNUSED_PRESERVE src0_sel:WORD_1
    v_mfma_f32_32x32x16_bf16 v[92:107], v[40:43], v[156:159], v[92:107]
    v_pk_mul_f16 v168, v168, v204
    v_pk_mul_f16 v169, v169, v205
    s_waitcnt lgkmcnt(0)
    v_readfirstlane_b32 s76, v215
    v_pk_mul_f16 v170, v170, v206
    v_pk_mul_f16 v171, v171, v207
    ds_write_b64 v250, v[168:169] offset:0
    ds_write_b64 v250, v[170:171] offset:16
    v_mfma_f32_32x32x16_bf16 v[92:107], v[48:51], v[160:163], v[92:107]
    s_setprio 0
    s_cmp_gt_u32 s45, s76
    s_cbranch_scc0 LM_pg1
    s_setprio 1
    LM_pg1:
    v_cvt_pk_f16_f32 v172, v84, v85
    v_cvt_pk_f16_f32 v173, v86, v87
    s_waitcnt vmcnt(6)
    ds_read_b128 v[140:143], v243 offset:0
    ds_read_b128 v[144:147], v244 offset:0
    ds_read_b128 v[148:151], v245 offset:0
    ds_read_b128 v[152:155], v246 offset:0
    ds_read_b128 v[156:159], v247 offset:0
    v_cvt_pk_f16_f32 v174, v88, v89
    v_mul_f32 v200, s56, v200
    v_cvt_pk_f16_f32 v175, v90, v91
    v_cvt_pk_bf16_f32 v200, v200, v200
    v_and_b32 v200, s54, v200
    v_exp_f16 v208, v172
    v_mfma_f32_32x32x16_bf16 v[92:107], v[56:59], v[164:167], v[92:107]
    v_exp_f16 v209, v173
    v_mul_f32 v232, v232, v200
    v_exp_f16 v210, v174
    v_mul_f32 v233, v233, v200
    v_mul_f32 v234, v234, v200
    v_exp_f16 v211, v175
    v_cvt_pk_f16_f32 v202, v232, v233
    v_exp_f16_sdwa v208, v172 dst_sel:WORD_1 dst_unused:UNUSED_PRESERVE src0_sel:WORD_1
    v_cvt_pk_f16_f32 v203, v234, v234
    s_mov_b64 exec, s[50:51]
    ds_write_b64 v249, v[202:203] offset:64
    s_mov_b64 exec, -1
    ds_read_b64_tr_b16 v[184:185], v1 offset:0
    ds_read_b64_tr_b16 v[186:187], v1 offset:136
    ds_read_b64_tr_b16 v[188:189], v1 offset:544
    ds_read_b64_tr_b16 v[190:191], v1 offset:680
    v_exp_f16_sdwa v209, v173 dst_sel:WORD_1 dst_unused:UNUSED_PRESERVE src0_sel:WORD_1
    s_waitcnt lgkmcnt(14)
    v_and_b32 v227, 31, v223
    v_exp_f16_sdwa v210, v174 dst_sel:WORD_1 dst_unused:UNUSED_PRESERVE src0_sel:WORD_1
    v_mad_u32_u24 v223, v227, s58, v248
    v_lshl_add_u32 v228, v227, 4, s59
    v_exp_f16_sdwa v211, v175 dst_sel:WORD_1 dst_unused:UNUSED_PRESERVE src0_sel:WORD_1
    ds_read_b128 v[160:163], v223
    ds_read_b128 v[164:167], v223 offset:32
    ds_read_b96 v[228:230], v228
    v_pk_add_f16 v208, v208, s60
    v_pk_add_f16 v209, v209, s60
    v_lshlrev_b32 v222, 16, v220
    v_pk_add_f16 v210, v210, s60
    v_and_b32 v220, s54, v220
    v_pk_add_f16 v211, v211, s60
    v_rcp_f16_sdwa v208, v208 dst_sel:WORD_0 dst_unused:UNUSED_PRESERVE src0_sel:WORD_0
    v_rcp_f16_sdwa v209, v209 dst_sel:WORD_0 dst_unused:UNUSED_PRESERVE src0_sel:WORD_0
    v_rcp_f16_sdwa v210, v210 dst_sel:WORD_0 dst_unused:UNUSED_PRESERVE src0_sel:WORD_0
    ds_write_b16 v231, v253
    v_rcp_f16_sdwa v211, v211 dst_sel:WORD_0 dst_unused:UNUSED_PRESERVE src0_sel:WORD_0
    v_rcp_f16_sdwa v208, v208 dst_sel:WORD_1 dst_unused:UNUSED_PRESERVE src0_sel:WORD_1
    v_rcp_f16_sdwa v209, v209 dst_sel:WORD_1 dst_unused:UNUSED_PRESERVE src0_sel:WORD_1
    s_waitcnt lgkmcnt(4)
    v_mfma_f32_16x16x32_f16 v[216:219], v[184:187], v[192:195], v[216:219]
    v_rcp_f16_sdwa v210, v210 dst_sel:WORD_1 dst_unused:UNUSED_PRESERVE src0_sel:WORD_1
    v_rcp_f16_sdwa v211, v211 dst_sel:WORD_1 dst_unused:UNUSED_PRESERVE src0_sel:WORD_1
    v_pk_mul_f16 v172, v172, v208
    v_mfma_f32_16x16x32_f16 v[216:219], v[188:191], v[196:199], v[216:219]
    v_pk_mul_f16 v173, v173, v209
    v_pk_mul_f16 v174, v174, v210
    v_pk_mul_f16 v175, v175, v211
    ds_write_b64 v250, v[172:173] offset:32
    ds_write_b64 v250, v[174:175] offset:48
    ds_read_b64_tr_b16 v[184:185], v251 offset:0
    ds_read_b64_tr_b16 v[186:187], v251 offset:136
    ds_read_b64_tr_b16 v[188:189], v251 offset:544
    ds_read_b64_tr_b16 v[190:191], v251 offset:680
    ds_read_b64_tr_b16 v[192:193], v251 offset:64
    ds_read_b64_tr_b16 v[194:195], v251 offset:200
    ds_read_b64_tr_b16 v[196:197], v251 offset:608
    ds_read_b64_tr_b16 v[198:199], v251 offset:744
    ds_write_b16 v231, v254
    s_cmp_eq_u32 s45, s26
    s_cbranch_scc1 LM_tail1
    s_cmp_eq_u32 s45, 2
    s_cselect_b32 s24, s25, 128
    v_add_u32 v3, s24, v3
    ds_read_b128 v[212:215], v3 offset:11264
    ds_read_b32 v238, v252 offset:27904
    ds_read_b32 v239, v2 offset:11520
    v_cvt_pk_f16_f32 v176, v92, v93
    v_cvt_pk_f16_f32 v177, v94, v95
    s_waitcnt lgkmcnt(15)
    v_sub_f32 v228, v228, v222
    v_cvt_pk_f16_f32 v178, v96, v97
    v_sub_f32 v229, v229, v220
    v_cvt_pk_f16_f32 v179, v98, v99
    v_sub_f32 v230, v230, v221
    v_mfma_f32_32x32x16_bf16 v[76:91], v[4:7], v[140:143], 0
    v_exp_f16 v204, v176
    v_cvt_pk_bf16_f32 v228, v228, v229
    v_exp_f16 v205, v177
    v_cvt_pk_bf16_f32 v230, v230, v230
    v_exp_f16 v206, v178
    v_lshlrev_b32 v232, 16, v228
    s_waitcnt lgkmcnt(4)
    v_mfma_f32_32x32x16_f16 v[108:123], v[184:187], v[192:195], v[108:123]
    v_exp_f16 v207, v179
    v_and_b32 v233, s54, v228
    v_exp_f16_sdwa v204, v176 dst_sel:WORD_1 dst_unused:UNUSED_PRESERVE src0_sel:WORD_1
    v_lshlrev_b32 v234, 16, v230
    v_exp_f16_sdwa v205, v177 dst_sel:WORD_1 dst_unused:UNUSED_PRESERVE src0_sel:WORD_1
    v_mfma_f32_32x32x16_bf16 v[76:91], v[12:15], v[144:147], v[76:91]
    v_exp_f16_sdwa v206, v178 dst_sel:WORD_1 dst_unused:UNUSED_PRESERVE src0_sel:WORD_1
    v_mul_f32 v229, v232, v232
    v_fma_f32 v229, v233, v233, v229
    v_exp_f16_sdwa v207, v179 dst_sel:WORD_1 dst_unused:UNUSED_PRESERVE src0_sel:WORD_1
    v_fma_f32 v229, v234, v234, v229
    v_pk_add_f16 v204, v204, s60
    v_mfma_f32_32x32x16_f16 v[108:123], v[188:191], v[196:199], v[108:123]
    v_pk_add_f16 v205, v205, s60
    v_cvt_pk_bf16_f32 v229, v229, v229
    v_bfi_b32 v167, v255, v229, v167
    v_pk_add_f16 v206, v206, s60
    v_lshl_add_u32 v231, v227, 1, v249
    v_pk_add_f16 v207, v207, s60
    v_mfma_f32_32x32x16_bf16 v[76:91], v[20:23], v[148:151], v[76:91]
    v_rcp_f16_sdwa v204, v204 dst_sel:WORD_0 dst_unused:UNUSED_PRESERVE src0_sel:WORD_0
    s_waitcnt lgkmcnt(0)
    v_and_or_b32 v212, v212, s55, v240
    v_rcp_f16_sdwa v205, v205 dst_sel:WORD_0 dst_unused:UNUSED_PRESERVE src0_sel:WORD_0
    v_mfma_f32_16x16x32_f16 v[200:203], v[60:63], v[168:171], 0
    v_and_or_b32 v213, v213, s55, v241
    v_rcp_f16_sdwa v206, v206 dst_sel:WORD_0 dst_unused:UNUSED_PRESERVE src0_sel:WORD_0
    v_and_or_b32 v214, v214, s55, v240
    v_rcp_f16_sdwa v207, v207 dst_sel:WORD_0 dst_unused:UNUSED_PRESERVE src0_sel:WORD_0
    v_and_or_b32 v215, v215, s55, v241
    v_rcp_f16_sdwa v204, v204 dst_sel:WORD_1 dst_unused:UNUSED_PRESERVE src0_sel:WORD_1
    v_mfma_f32_32x32x16_bf16 v[76:91], v[28:31], v[152:155], v[76:91]
    v_lshl_add_u32 v238, v238, 5, v242
    v_rcp_f16_sdwa v205, v205 dst_sel:WORD_1 dst_unused:UNUSED_PRESERVE src0_sel:WORD_1
    v_bfe_u32 v239, v239, 7, 16
    v_rcp_f16_sdwa v206, v206 dst_sel:WORD_1 dst_unused:UNUSED_PRESERVE src0_sel:WORD_1
    v_rcp_f16_sdwa v207, v207 dst_sel:WORD_1 dst_unused:UNUSED_PRESERVE src0_sel:WORD_1
    v_mfma_f32_16x16x32_f16 v[200:203], v[64:67], v[172:175], v[200:203]
    v_pk_mul_f16 v176, v176, v204
    s_cmp_lt_u32 s45, 4
    s_cselect_b32 s27, 0, 6400000
    s_cselect_b32 s14, 0, s14
    s_cselect_b32 s22, 0, s22
    s_cmp_eq_u32 s45, 2
    s_cselect_b32 s10, 6400000, s27
    v_pk_mul_f16 v177, v177, v205
    v_mfma_f32_32x32x16_bf16 v[76:91], v[36:39], v[156:159], v[76:91]
    v_pk_mul_f16 v178, v178, v206
    v_pk_mul_f16 v179, v179, v207
    ds_write_b64 v250, v[176:177] offset:0
    ds_write_b64 v250, v[178:179] offset:16
    v_cvt_pk_f16_f32 v180, v100, v101
    v_cvt_pk_f16_f32 v181, v102, v103
    v_cvt_pk_f16_f32 v182, v104, v105
    v_mfma_f32_32x32x16_bf16 v[76:91], v[44:47], v[160:163], v[76:91]
    s_add_u32 m0, s47, 0
    v_cvt_pk_f16_f32 v183, v106, v107
    buffer_load_dwordx4 v212, s[8:11], 0 offen lds
    v_exp_f16 v208, v180
    v_exp_f16 v209, v181
    s_add_u32 m0, s47, 1024
    v_exp_f16 v210, v182
    buffer_load_dwordx4 v213, s[8:11], 0 offen lds
    v_exp_f16 v211, v183
    v_mfma_f32_32x32x16_bf16 v[76:91], v[52:55], v[164:167], v[76:91]
    v_exp_f16_sdwa v208, v180 dst_sel:WORD_1 dst_unused:UNUSED_PRESERVE src0_sel:WORD_1
    s_add_u32 m0, s47, 2048
    v_exp_f16_sdwa v209, v181 dst_sel:WORD_1 dst_unused:UNUSED_PRESERVE src0_sel:WORD_1
    buffer_load_dwordx4 v214, s[8:11], 0 offen lds
    v_exp_f16_sdwa v210, v182 dst_sel:WORD_1 dst_unused:UNUSED_PRESERVE src0_sel:WORD_1
    s_add_u32 m0, s47, 3072
    v_exp_f16_sdwa v211, v183 dst_sel:WORD_1 dst_unused:UNUSED_PRESERVE src0_sel:WORD_1
    buffer_load_dwordx4 v215, s[8:11], 0 offen lds
    v_pk_add_f16 v208, v208, s60
    s_add_u32 m0, s47, 4096
    v_pk_add_f16 v209, v209, s60
    buffer_load_dwordx4 v238, s[12:15], 0 offen lds
    v_pk_add_f16 v210, v210, s60
    v_pk_add_f16 v211, v211, s60
    s_mov_b64 exec, s[50:51]
    buffer_load_dwordx2 v[220:221], v239, s[20:23], s57 idxen
    s_mov_b64 exec, -1
    v_rcp_f16_sdwa v208, v208 dst_sel:WORD_0 dst_unused:UNUSED_PRESERVE src0_sel:WORD_0
    v_rcp_f16_sdwa v209, v209 dst_sel:WORD_0 dst_unused:UNUSED_PRESERVE src0_sel:WORD_0
    v_rcp_f16_sdwa v210, v210 dst_sel:WORD_0 dst_unused:UNUSED_PRESERVE src0_sel:WORD_0
    v_add_u32 v2, 256, v2
    v_rcp_f16_sdwa v211, v211 dst_sel:WORD_0 dst_unused:UNUSED_PRESERVE src0_sel:WORD_0
    v_rcp_f16_sdwa v208, v208 dst_sel:WORD_1 dst_unused:UNUSED_PRESERVE src0_sel:WORD_1
    v_rcp_f16_sdwa v209, v209 dst_sel:WORD_1 dst_unused:UNUSED_PRESERVE src0_sel:WORD_1
    v_add_u32 v252, 256, v252
    v_rcp_f16_sdwa v210, v210 dst_sel:WORD_1 dst_unused:UNUSED_PRESERVE src0_sel:WORD_1
    v_rcp_f16_sdwa v211, v211 dst_sel:WORD_1 dst_unused:UNUSED_PRESERVE src0_sel:WORD_1
    v_pk_mul_f16 v180, v180, v208
    v_pk_mul_f16 v181, v181, v209
    v_pk_mul_f16 v182, v182, v210
    v_pk_mul_f16 v183, v183, v211
    ds_write_b64 v250, v[180:181] offset:32
    ds_write_b64 v250, v[182:183] offset:48
    ds_read_b64_tr_b16 v[184:185], v251 offset:0
    ds_read_b64_tr_b16 v[186:187], v251 offset:136
    ds_read_b64_tr_b16 v[188:189], v251 offset:544
    ds_read_b64_tr_b16 v[190:191], v251 offset:680
    s_sub_u32 s45, s45, 1
    s_cmp_lg_u32 s45, 0
    s_cbranch_scc1 LM_loop
    s_waitcnt lgkmcnt(0)
    v_mfma_f32_32x32x16_f16 v[124:139], v[184:187], v[192:195], v[124:139]
    v_mfma_f32_32x32x16_f16 v[124:139], v[188:191], v[196:199], v[124:139]
    v_mfma_f32_16x16x32_f16 v[200:203], v[68:71], v[176:179], v[200:203]
    v_mfma_f32_16x16x32_f16 v[200:203], v[72:75], v[180:183], v[200:203]
    s_nop 9
    v_mul_f32 v200, s56, v200
    v_cvt_pk_bf16_f32 v200, v200, v200
    v_and_b32 v200, s54, v200
    v_mul_f32 v235, v235, v200
    v_mul_f32 v236, v236, v200
    v_mul_f32 v237, v237, v200
    v_cvt_pk_f16_f32 v202, v235, v236
    v_cvt_pk_f16_f32 v203, v237, v237
    s_mov_b64 exec, s[50:51]
    ds_write_b64 v249, v[202:203] offset:64
    s_mov_b64 exec, -1
    ds_read_b64_tr_b16 v[184:185], v1 offset:0
    ds_read_b64_tr_b16 v[186:187], v1 offset:136
    ds_read_b64_tr_b16 v[188:189], v1 offset:544
    ds_read_b64_tr_b16 v[190:191], v1 offset:680
    s_waitcnt lgkmcnt(0)
    v_mfma_f32_16x16x32_f16 v[216:219], v[184:187], v[192:195], v[216:219]
    v_mfma_f32_16x16x32_f16 v[216:219], v[188:191], v[196:199], v[216:219]
    s_branch LM_tiles_done
LM_tail0:
    v_and_b32 v212, 63, v0
    v_lshlrev_b32 v212, 4, v212
    s_mov_b32 s28, 21272576
    s_mov_b32 s29, 21276672
    s_mov_b32 s30, 21280768
    s_mov_b32 s31, 21284864
    s_mov_b32 s27, 0
    v_cvt_pk_f16_f32 v176, v92, v93
    v_cvt_pk_f16_f32 v177, v94, v95
    buffer_load_dwordx4 v[36:39], v212, s[16:19], s30 offen offset:0
    v_cvt_pk_f16_f32 v178, v96, v97
    v_cvt_pk_f16_f32 v179, v98, v99
    buffer_load_dwordx4 v[40:43], v212, s[16:19], s30 offen offset:1024
    v_exp_f16 v204, v176
    buffer_load_dwordx4 v[44:47], v212, s[16:19], s30 offen offset:2048
    v_exp_f16 v205, v177
    v_exp_f16 v206, v178
    s_waitcnt lgkmcnt(1)
    v_mfma_f32_32x32x16_f16 v[108:123], v[184:187], v[192:195], v[108:123]
    v_exp_f16 v207, v179
    buffer_load_dwordx4 v[48:51], v212, s[16:19], s30 offen offset:3072
    v_exp_f16_sdwa v204, v176 dst_sel:WORD_1 dst_unused:UNUSED_PRESERVE src0_sel:WORD_1
    v_exp_f16_sdwa v205, v177 dst_sel:WORD_1 dst_unused:UNUSED_PRESERVE src0_sel:WORD_1
    buffer_load_dwordx4 v[52:55], v212, s[16:19], s31 offen offset:0
    v_exp_f16_sdwa v206, v178 dst_sel:WORD_1 dst_unused:UNUSED_PRESERVE src0_sel:WORD_1
    buffer_load_dwordx4 v[56:59], v212, s[16:19], s31 offen offset:1024
    v_exp_f16_sdwa v207, v179 dst_sel:WORD_1 dst_unused:UNUSED_PRESERVE src0_sel:WORD_1
    v_pk_add_f16 v204, v204, s60
    v_mfma_f32_32x32x16_f16 v[108:123], v[188:191], v[196:199], v[108:123]
    buffer_load_dwordx4 v[160:163], v212, s[16:19], s31 offen offset:2048
    v_pk_add_f16 v205, v205, s60
    buffer_load_dwordx4 v[164:167], v212, s[16:19], s31 offen offset:3072
    v_pk_add_f16 v206, v206, s60
    v_pk_add_f16 v207, v207, s60
    buffer_load_dwordx4 v[4:7], v212, s[16:19], s28 offen offset:0
    v_rcp_f16_sdwa v204, v204 dst_sel:WORD_0 dst_unused:UNUSED_PRESERVE src0_sel:WORD_0
    v_rcp_f16_sdwa v205, v205 dst_sel:WORD_0 dst_unused:UNUSED_PRESERVE src0_sel:WORD_0
    v_mfma_f32_16x16x32_f16 v[200:203], v[60:63], v[168:171], 0
    buffer_load_dwordx4 v[8:11], v212, s[16:19], s28 offen offset:1024
    v_rcp_f16_sdwa v206, v206 dst_sel:WORD_0 dst_unused:UNUSED_PRESERVE src0_sel:WORD_0
    buffer_load_dwordx4 v[12:15], v212, s[16:19], s28 offen offset:2048
    v_rcp_f16_sdwa v207, v207 dst_sel:WORD_0 dst_unused:UNUSED_PRESERVE src0_sel:WORD_0
    v_rcp_f16_sdwa v204, v204 dst_sel:WORD_1 dst_unused:UNUSED_PRESERVE src0_sel:WORD_1
    buffer_load_dwordx4 v[16:19], v212, s[16:19], s28 offen offset:3072
    v_rcp_f16_sdwa v205, v205 dst_sel:WORD_1 dst_unused:UNUSED_PRESERVE src0_sel:WORD_1
    buffer_load_dwordx4 v[20:23], v212, s[16:19], s29 offen offset:0
    v_rcp_f16_sdwa v206, v206 dst_sel:WORD_1 dst_unused:UNUSED_PRESERVE src0_sel:WORD_1
    v_rcp_f16_sdwa v207, v207 dst_sel:WORD_1 dst_unused:UNUSED_PRESERVE src0_sel:WORD_1
    v_mfma_f32_16x16x32_f16 v[200:203], v[64:67], v[172:175], v[200:203]
    buffer_load_dwordx4 v[24:27], v212, s[16:19], s29 offen offset:1024
    v_pk_mul_f16 v176, v176, v204
    buffer_load_dwordx4 v[28:31], v212, s[16:19], s29 offen offset:2048
    v_pk_mul_f16 v177, v177, v205
    v_pk_mul_f16 v178, v178, v206
    buffer_load_dwordx4 v[32:35], v212, s[16:19], s29 offen offset:3072
    v_pk_mul_f16 v179, v179, v207
    ds_write_b64 v250, v[176:177] offset:0
    ds_write_b64 v250, v[178:179] offset:16
    v_cvt_pk_f16_f32 v180, v100, v101
    v_cvt_pk_f16_f32 v181, v102, v103
    v_cvt_pk_f16_f32 v182, v104, v105
    v_cvt_pk_f16_f32 v183, v106, v107
    v_exp_f16 v208, v180
    v_exp_f16 v209, v181
    v_exp_f16 v210, v182
    v_exp_f16 v211, v183
    v_exp_f16_sdwa v208, v180 dst_sel:WORD_1 dst_unused:UNUSED_PRESERVE src0_sel:WORD_1
    v_exp_f16_sdwa v209, v181 dst_sel:WORD_1 dst_unused:UNUSED_PRESERVE src0_sel:WORD_1
    v_exp_f16_sdwa v210, v182 dst_sel:WORD_1 dst_unused:UNUSED_PRESERVE src0_sel:WORD_1
    v_exp_f16_sdwa v211, v183 dst_sel:WORD_1 dst_unused:UNUSED_PRESERVE src0_sel:WORD_1
    v_pk_add_f16 v208, v208, s60
    s_waitcnt vmcnt(16)
    ds_read_b128 v[140:143], v243 offset:0
    ds_read_b128 v[144:147], v244 offset:0
    ds_read_b128 v[148:151], v245 offset:0
    ds_read_b128 v[152:155], v246 offset:0
    v_pk_add_f16 v209, v209, s60
    v_pk_add_f16 v210, v210, s60
    v_pk_add_f16 v211, v211, s60
    v_rcp_f16_sdwa v208, v208 dst_sel:WORD_0 dst_unused:UNUSED_PRESERVE src0_sel:WORD_0
    v_rcp_f16_sdwa v209, v209 dst_sel:WORD_0 dst_unused:UNUSED_PRESERVE src0_sel:WORD_0
    v_rcp_f16_sdwa v210, v210 dst_sel:WORD_0 dst_unused:UNUSED_PRESERVE src0_sel:WORD_0
    v_rcp_f16_sdwa v211, v211 dst_sel:WORD_0 dst_unused:UNUSED_PRESERVE src0_sel:WORD_0
    v_rcp_f16_sdwa v208, v208 dst_sel:WORD_1 dst_unused:UNUSED_PRESERVE src0_sel:WORD_1
    v_rcp_f16_sdwa v209, v209 dst_sel:WORD_1 dst_unused:UNUSED_PRESERVE src0_sel:WORD_1
    v_rcp_f16_sdwa v210, v210 dst_sel:WORD_1 dst_unused:UNUSED_PRESERVE src0_sel:WORD_1
    v_rcp_f16_sdwa v211, v211 dst_sel:WORD_1 dst_unused:UNUSED_PRESERVE src0_sel:WORD_1
    v_pk_mul_f16 v180, v180, v208
    v_pk_mul_f16 v181, v181, v209
    v_pk_mul_f16 v182, v182, v210
    v_pk_mul_f16 v183, v183, v211
    ds_write_b64 v250, v[180:181] offset:32
    ds_write_b64 v250, v[182:183] offset:48
    ds_read_b64_tr_b16 v[184:185], v251 offset:0
    ds_read_b64_tr_b16 v[186:187], v251 offset:136
    ds_read_b64_tr_b16 v[188:189], v251 offset:544
    ds_read_b64_tr_b16 v[190:191], v251 offset:680
    s_waitcnt lgkmcnt(0)
    v_mfma_f32_32x32x16_f16 v[124:139], v[184:187], v[192:195], v[124:139]
    v_mfma_f32_32x32x16_f16 v[124:139], v[188:191], v[196:199], v[124:139]
    v_mfma_f32_16x16x32_f16 v[200:203], v[68:71], v[176:179], v[200:203]
    v_mfma_f32_16x16x32_f16 v[200:203], v[72:75], v[180:183], v[200:203]
    s_nop 9
    v_mul_f32 v200, s56, v200
    v_cvt_pk_bf16_f32 v200, v200, v200
    v_and_b32 v200, s54, v200
    v_mul_f32 v232, v232, v200
    v_mul_f32 v233, v233, v200
    v_mul_f32 v234, v234, v200
    v_cvt_pk_f16_f32 v202, v232, v233
    v_cvt_pk_f16_f32 v203, v234, v234
    s_mov_b64 exec, s[50:51]
    ds_write_b64 v249, v[202:203] offset:64
    s_mov_b64 exec, -1
    ds_read_b64_tr_b16 v[184:185], v1 offset:0
    ds_read_b64_tr_b16 v[186:187], v1 offset:136
    ds_read_b64_tr_b16 v[188:189], v1 offset:544
    ds_read_b64_tr_b16 v[190:191], v1 offset:680
    s_waitcnt lgkmcnt(0)
    v_mfma_f32_16x16x32_f16 v[216:219], v[184:187], v[192:195], v[216:219]
    v_mfma_f32_16x16x32_f16 v[216:219], v[188:191], v[196:199], v[216:219]
    s_branch LM_epif
LM_tail1:
    v_and_b32 v212, 63, v0
    v_lshlrev_b32 v212, 4, v212
    s_mov_b32 s28, 21272576
    s_mov_b32 s29, 21276672
    s_mov_b32 s30, 21280768
    s_mov_b32 s31, 21284864
    s_mov_b32 s27, 5120
    v_cvt_pk_f16_f32 v176, v92, v93
    v_cvt_pk_f16_f32 v177, v94, v95
    buffer_load_dwordx4 v[36:39], v212, s[16:19], s30 offen offset:0
    v_cvt_pk_f16_f32 v178, v96, v97
    v_cvt_pk_f16_f32 v179, v98, v99
    buffer_load_dwordx4 v[40:43], v212, s[16:19], s30 offen offset:1024
    v_exp_f16 v204, v176
    buffer_load_dwordx4 v[44:47], v212, s[16:19], s30 offen offset:2048
    v_exp_f16 v205, v177
    v_exp_f16 v206, v178
    s_waitcnt lgkmcnt(1)
    v_mfma_f32_32x32x16_f16 v[108:123], v[184:187], v[192:195], v[108:123]
    v_exp_f16 v207, v179
    buffer_load_dwordx4 v[48:51], v212, s[16:19], s30 offen offset:3072
    v_exp_f16_sdwa v204, v176 dst_sel:WORD_1 dst_unused:UNUSED_PRESERVE src0_sel:WORD_1
    v_exp_f16_sdwa v205, v177 dst_sel:WORD_1 dst_unused:UNUSED_PRESERVE src0_sel:WORD_1
    buffer_load_dwordx4 v[52:55], v212, s[16:19], s31 offen offset:0
    v_exp_f16_sdwa v206, v178 dst_sel:WORD_1 dst_unused:UNUSED_PRESERVE src0_sel:WORD_1
    buffer_load_dwordx4 v[56:59], v212, s[16:19], s31 offen offset:1024
    v_exp_f16_sdwa v207, v179 dst_sel:WORD_1 dst_unused:UNUSED_PRESERVE src0_sel:WORD_1
    v_pk_add_f16 v204, v204, s60
    v_mfma_f32_32x32x16_f16 v[108:123], v[188:191], v[196:199], v[108:123]
    buffer_load_dwordx4 v[160:163], v212, s[16:19], s31 offen offset:2048
    v_pk_add_f16 v205, v205, s60
    buffer_load_dwordx4 v[164:167], v212, s[16:19], s31 offen offset:3072
    v_pk_add_f16 v206, v206, s60
    v_pk_add_f16 v207, v207, s60
    buffer_load_dwordx4 v[4:7], v212, s[16:19], s28 offen offset:0
    v_rcp_f16_sdwa v204, v204 dst_sel:WORD_0 dst_unused:UNUSED_PRESERVE src0_sel:WORD_0
    v_rcp_f16_sdwa v205, v205 dst_sel:WORD_0 dst_unused:UNUSED_PRESERVE src0_sel:WORD_0
    v_mfma_f32_16x16x32_f16 v[200:203], v[60:63], v[168:171], 0
    buffer_load_dwordx4 v[8:11], v212, s[16:19], s28 offen offset:1024
    v_rcp_f16_sdwa v206, v206 dst_sel:WORD_0 dst_unused:UNUSED_PRESERVE src0_sel:WORD_0
    buffer_load_dwordx4 v[12:15], v212, s[16:19], s28 offen offset:2048
    v_rcp_f16_sdwa v207, v207 dst_sel:WORD_0 dst_unused:UNUSED_PRESERVE src0_sel:WORD_0
    v_rcp_f16_sdwa v204, v204 dst_sel:WORD_1 dst_unused:UNUSED_PRESERVE src0_sel:WORD_1
    buffer_load_dwordx4 v[16:19], v212, s[16:19], s28 offen offset:3072
    v_rcp_f16_sdwa v205, v205 dst_sel:WORD_1 dst_unused:UNUSED_PRESERVE src0_sel:WORD_1
    buffer_load_dwordx4 v[20:23], v212, s[16:19], s29 offen offset:0
    v_rcp_f16_sdwa v206, v206 dst_sel:WORD_1 dst_unused:UNUSED_PRESERVE src0_sel:WORD_1
    v_rcp_f16_sdwa v207, v207 dst_sel:WORD_1 dst_unused:UNUSED_PRESERVE src0_sel:WORD_1
    v_mfma_f32_16x16x32_f16 v[200:203], v[64:67], v[172:175], v[200:203]
    buffer_load_dwordx4 v[24:27], v212, s[16:19], s29 offen offset:1024
    v_pk_mul_f16 v176, v176, v204
    buffer_load_dwordx4 v[28:31], v212, s[16:19], s29 offen offset:2048
    v_pk_mul_f16 v177, v177, v205
    v_pk_mul_f16 v178, v178, v206
    buffer_load_dwordx4 v[32:35], v212, s[16:19], s29 offen offset:3072
    v_pk_mul_f16 v179, v179, v207
    ds_write_b64 v250, v[176:177] offset:0
    ds_write_b64 v250, v[178:179] offset:16
    v_cvt_pk_f16_f32 v180, v100, v101
    v_cvt_pk_f16_f32 v181, v102, v103
    v_cvt_pk_f16_f32 v182, v104, v105
    v_cvt_pk_f16_f32 v183, v106, v107
    v_exp_f16 v208, v180
    v_exp_f16 v209, v181
    v_exp_f16 v210, v182
    v_exp_f16 v211, v183
    v_exp_f16_sdwa v208, v180 dst_sel:WORD_1 dst_unused:UNUSED_PRESERVE src0_sel:WORD_1
    v_exp_f16_sdwa v209, v181 dst_sel:WORD_1 dst_unused:UNUSED_PRESERVE src0_sel:WORD_1
    v_exp_f16_sdwa v210, v182 dst_sel:WORD_1 dst_unused:UNUSED_PRESERVE src0_sel:WORD_1
    v_exp_f16_sdwa v211, v183 dst_sel:WORD_1 dst_unused:UNUSED_PRESERVE src0_sel:WORD_1
    v_pk_add_f16 v208, v208, s60
    s_waitcnt vmcnt(16)
    ds_read_b128 v[140:143], v243 offset:5120
    ds_read_b128 v[144:147], v244 offset:5120
    ds_read_b128 v[148:151], v245 offset:5120
    ds_read_b128 v[152:155], v246 offset:5120
    v_pk_add_f16 v209, v209, s60
    v_pk_add_f16 v210, v210, s60
    v_pk_add_f16 v211, v211, s60
    v_rcp_f16_sdwa v208, v208 dst_sel:WORD_0 dst_unused:UNUSED_PRESERVE src0_sel:WORD_0
    v_rcp_f16_sdwa v209, v209 dst_sel:WORD_0 dst_unused:UNUSED_PRESERVE src0_sel:WORD_0
    v_rcp_f16_sdwa v210, v210 dst_sel:WORD_0 dst_unused:UNUSED_PRESERVE src0_sel:WORD_0
    v_rcp_f16_sdwa v211, v211 dst_sel:WORD_0 dst_unused:UNUSED_PRESERVE src0_sel:WORD_0
    v_rcp_f16_sdwa v208, v208 dst_sel:WORD_1 dst_unused:UNUSED_PRESERVE src0_sel:WORD_1
    v_rcp_f16_sdwa v209, v209 dst_sel:WORD_1 dst_unused:UNUSED_PRESERVE src0_sel:WORD_1
    v_rcp_f16_sdwa v210, v210 dst_sel:WORD_1 dst_unused:UNUSED_PRESERVE src0_sel:WORD_1
    v_rcp_f16_sdwa v211, v211 dst_sel:WORD_1 dst_unused:UNUSED_PRESERVE src0_sel:WORD_1
    v_pk_mul_f16 v180, v180, v208
    v_pk_mul_f16 v181, v181, v209
    v_pk_mul_f16 v182, v182, v210
    v_pk_mul_f16 v183, v183, v211
    ds_write_b64 v250, v[180:181] offset:32
    ds_write_b64 v250, v[182:183] offset:48
    ds_read_b64_tr_b16 v[184:185], v251 offset:0
    ds_read_b64_tr_b16 v[186:187], v251 offset:136
    ds_read_b64_tr_b16 v[188:189], v251 offset:544
    ds_read_b64_tr_b16 v[190:191], v251 offset:680
    s_waitcnt lgkmcnt(0)
    v_mfma_f32_32x32x16_f16 v[124:139], v[184:187], v[192:195], v[124:139]
    v_mfma_f32_32x32x16_f16 v[124:139], v[188:191], v[196:199], v[124:139]
    v_mfma_f32_16x16x32_f16 v[200:203], v[68:71], v[176:179], v[200:203]
    v_mfma_f32_16x16x32_f16 v[200:203], v[72:75], v[180:183], v[200:203]
    s_nop 9
    v_mul_f32 v200, s56, v200
    v_cvt_pk_bf16_f32 v200, v200, v200
    v_and_b32 v200, s54, v200
    v_mul_f32 v235, v235, v200
    v_mul_f32 v236, v236, v200
    v_mul_f32 v237, v237, v200
    v_cvt_pk_f16_f32 v202, v235, v236
    v_cvt_pk_f16_f32 v203, v237, v237
    s_mov_b64 exec, s[50:51]
    ds_write_b64 v249, v[202:203] offset:64
    s_mov_b64 exec, -1
    ds_read_b64_tr_b16 v[184:185], v1 offset:0
    ds_read_b64_tr_b16 v[186:187], v1 offset:136
    ds_read_b64_tr_b16 v[188:189], v1 offset:544
    ds_read_b64_tr_b16 v[190:191], v1 offset:680
    s_waitcnt lgkmcnt(0)
    v_mfma_f32_16x16x32_f16 v[216:219], v[184:187], v[192:195], v[216:219]
    v_mfma_f32_16x16x32_f16 v[216:219], v[188:191], v[196:199], v[216:219]
    s_branch LM_epif
LM_nt0:
    s_barrier
    s_branch LM_tiles_done
LM_drain0:
    s_waitcnt lgkmcnt(0)
    v_mfma_f32_32x32x16_f16 v[124:139], v[184:187], v[192:195], v[124:139]
    v_mfma_f32_32x32x16_f16 v[124:139], v[188:191], v[196:199], v[124:139]
    v_mfma_f32_16x16x32_f16 v[200:203], v[68:71], v[176:179], v[200:203]
    v_mfma_f32_16x16x32_f16 v[200:203], v[72:75], v[180:183], v[200:203]
    s_nop 9
    v_mul_f32 v200, s56, v200
    v_cvt_pk_bf16_f32 v200, v200, v200
    v_and_b32 v200, s54, v200
    v_mul_f32 v232, v232, v200
    v_mul_f32 v233, v233, v200
    v_mul_f32 v234, v234, v200
    v_cvt_pk_f16_f32 v202, v232, v233
    v_cvt_pk_f16_f32 v203, v234, v234
    s_mov_b64 exec, s[50:51]
    ds_write_b64 v249, v[202:203] offset:64
    s_mov_b64 exec, -1
    ds_read_b64_tr_b16 v[184:185], v1 offset:0
    ds_read_b64_tr_b16 v[186:187], v1 offset:136
    ds_read_b64_tr_b16 v[188:189], v1 offset:544
    ds_read_b64_tr_b16 v[190:191], v1 offset:680
    s_waitcnt lgkmcnt(0)
    v_mfma_f32_16x16x32_f16 v[216:219], v[184:187], v[192:195], v[216:219]
    v_mfma_f32_16x16x32_f16 v[216:219], v[188:191], v[196:199], v[216:219]
LM_tiles_done:
    s_mov_b32 s10, 6400000
    s_mov_b32 s14, 25600000
    s_mov_b32 s22, 50000
    s_waitcnt vmcnt(0) lgkmcnt(0)
    s_add_u32 s42, s42, 512
    s_cmp_ge_u32 s42, s41
    s_cbranch_scc1 LM_epi
    v_and_b32 v208, 63, v0
    v_and_b32 v209, 31, v0
    v_bfe_u32 v210, v0, 5, 1
    v_lshlrev_b32 v211, 4, v210
    v_lshlrev_b32 v212, 4, v208
    v_lshlrev_b32 v213, 2, v0
    s_branch LM_slowbase
LM_epi:
    v_and_b32 v220, 31, v0
    v_bfe_u32 v221, v0, 5, 1
    v_add_u32 v213, s46, v220
    v_lshlrev_b32 v214, 7, v213
    v_lshl_add_u32 v214, v221, 3, v214
    v_lshlrev_b32 v222, 4, v221
    v_and_b32 v212, 63, v0
    v_lshlrev_b32 v212, 4, v212
    s_mov_b32 s28, 21272576
    s_mov_b32 s29, 21276672
    s_mov_b32 s30, 21280768
    s_mov_b32 s31, 21284864
    buffer_load_dwordx4 v[36:39], v212, s[16:19], s30 offen offset:0
    buffer_load_dwordx4 v[40:43], v212, s[16:19], s30 offen offset:1024
    buffer_load_dwordx4 v[44:47], v212, s[16:19], s30 offen offset:2048
    buffer_load_dwordx4 v[48:51], v212, s[16:19], s30 offen offset:3072
    buffer_load_dwordx4 v[52:55], v212, s[16:19], s31 offen offset:0
    buffer_load_dwordx4 v[56:59], v212, s[16:19], s31 offen offset:1024
    buffer_load_dwordx4 v[160:163], v212, s[16:19], s31 offen offset:2048
    buffer_load_dwordx4 v[164:167], v212, s[16:19], s31 offen offset:3072
    buffer_load_dwordx4 v[4:7], v212, s[16:19], s28 offen offset:0
    buffer_load_dwordx4 v[8:11], v212, s[16:19], s28 offen offset:1024
    buffer_load_dwordx4 v[12:15], v212, s[16:19], s28 offen offset:2048
    buffer_load_dwordx4 v[16:19], v212, s[16:19], s28 offen offset:3072
    buffer_load_dwordx4 v[20:23], v212, s[16:19], s29 offen offset:0
    buffer_load_dwordx4 v[24:27], v212, s[16:19], s29 offen offset:1024
    buffer_load_dwordx4 v[28:31], v212, s[16:19], s29 offen offset:2048
    buffer_load_dwordx4 v[32:35], v212, s[16:19], s29 offen offset:3072
    v_lshl_add_u32 v224, v213, 7, v222
    buffer_load_dwordx4 v[140:143], v224, s[8:11], 0 offen offset:0
    buffer_load_dwordx4 v[144:147], v224, s[8:11], 0 offen offset:32
    buffer_load_dwordx4 v[148:151], v224, s[8:11], 0 offen offset:64
    buffer_load_dwordx4 v[152:155], v224, s[8:11], 0 offen offset:96
    buffer_load_dwordx2 v[184:185], v214, s[8:11], 0 offen offset:0
    buffer_load_dwordx2 v[186:187], v214, s[8:11], 0 offen offset:16
    buffer_load_dwordx2 v[188:189], v214, s[8:11], 0 offen offset:32
    buffer_load_dwordx2 v[190:191], v214, s[8:11], 0 offen offset:48
    buffer_load_dwordx2 v[192:193], v214, s[8:11], 0 offen offset:64
    buffer_load_dwordx2 v[194:195], v214, s[8:11], 0 offen offset:80
    buffer_load_dwordx2 v[196:197], v214, s[8:11], 0 offen offset:96
    buffer_load_dwordx2 v[198:199], v214, s[8:11], 0 offen offset:112
    s_mov_b32 s27, s47
    v_lshrrev_b32 v224, 3, v220
    v_and_b32 v222, 7, v220
    v_lshl_add_u32 v215, v224, 10, s27
    v_lshl_add_u32 v215, v222, 7, v215
    v_lshl_add_u32 v215, v221, 3, v215
    v_and_b32 v224, 1, v224
    v_xor_b32 v224, v224, v222
    v_lshl_add_u32 v215, v224, 4, v215
    v_xor_b32 v60, 0, v215
    v_xor_b32 v61, 16, v215
    v_xor_b32 v62, 32, v215
    v_xor_b32 v63, 48, v215
    v_xor_b32 v64, 64, v215
    v_xor_b32 v65, 80, v215
    v_xor_b32 v66, 96, v215
    v_xor_b32 v67, 112, v215
    v_and_b32 v68, 63, v0
    v_lshl_add_u32 v69, v68, 4, s27
    v_lshrrev_b32 v68, 3, v68
    v_add_u32 v68, s46, v68
    v_lshl_add_u32 v70, v68, 7, v240
    v_lshl_add_u32 v71, v68, 7, v241
    s_mov_b32 s82, s56
    s_mov_b32 s83, s56
    s_mov_b32 s84, 0xbfb8aa3b
    s_mov_b32 s85, 0xbfb8aa3b
    s_mov_b32 s86, 1.0
    s_mov_b32 s87, 1.0
    v_pk_mul_f32 v[108:109], s[82:83], v[108:109]
    v_pk_mul_f32 v[110:111], s[82:83], v[110:111]
    v_pk_mul_f32 v[112:113], s[82:83], v[112:113]
    v_pk_mul_f32 v[114:115], s[82:83], v[114:115]
    v_pk_mul_f32 v[116:117], s[82:83], v[116:117]
    v_pk_mul_f32 v[118:119], s[82:83], v[118:119]
    v_pk_mul_f32 v[120:121], s[82:83], v[120:121]
    v_pk_mul_f32 v[122:123], s[82:83], v[122:123]
    v_pk_mul_f32 v[124:125], s[82:83], v[124:125]
    v_pk_mul_f32 v[126:127], s[82:83], v[126:127]
    v_pk_mul_f32 v[128:129], s[82:83], v[128:129]
    v_pk_mul_f32 v[130:131], s[82:83], v[130:131]
    v_pk_mul_f32 v[132:133], s[82:83], v[132:133]
    v_pk_mul_f32 v[134:135], s[82:83], v[134:135]
    v_pk_mul_f32 v[136:137], s[82:83], v[136:137]
    v_pk_mul_f32 v[138:139], s[82:83], v[138:139]
    v_cvt_pk_bf16_f32 v168, v108, v109
    v_cvt_pk_bf16_f32 v169, v110, v111
    v_cvt_pk_bf16_f32 v170, v112, v113
    v_cvt_pk_bf16_f32 v171, v114, v115
    v_cvt_pk_bf16_f32 v172, v116, v117
    v_cvt_pk_bf16_f32 v173, v118, v119
    v_cvt_pk_bf16_f32 v174, v120, v121
    v_cvt_pk_bf16_f32 v175, v122, v123
    v_cvt_pk_bf16_f32 v176, v124, v125
    v_cvt_pk_bf16_f32 v177, v126, v127
    v_cvt_pk_bf16_f32 v178, v128, v129
    v_cvt_pk_bf16_f32 v179, v130, v131
    v_cvt_pk_bf16_f32 v180, v132, v133
    v_cvt_pk_bf16_f32 v181, v134, v135
    v_cvt_pk_bf16_f32 v182, v136, v137
    v_cvt_pk_bf16_f32 v183, v138, v139
    s_mov_b64 exec, 0x01ffffff
    v_lshl_add_u32 v224, v220, 4, s59
    ds_read_b96 v[208:210], v224
    v_mul_u32_u24 v215, 6, v213
    v_add_u32 v215, 6400000, v215
    v_cvt_pk_bf16_f32 v200, v216, v217
    v_cvt_pk_bf16_f32 v201, v218, v218
    v_lshlrev_b32 v204, 16, v200
    v_and_b32 v205, s54, v200
    v_lshlrev_b32 v206, 16, v201
    s_waitcnt lgkmcnt(0)
    v_add_f32 v204, v204, v208
    v_add_f32 v205, v205, v209
    v_add_f32 v206, v206, v210
    v_cvt_pk_bf16_f32 v200, v204, v204
    v_cvt_pk_bf16_f32 v201, v205, v205
    v_cvt_pk_bf16_f32 v202, v206, v206
    buffer_store_short v200, v215, s[32:35], 0 offen offset:0 sc1
    buffer_store_short v201, v215, s[32:35], 0 offen offset:2 sc1
    buffer_store_short v202, v215, s[32:35], 0 offen offset:4 sc1
    s_mov_b64 exec, -1
    s_waitcnt vmcnt(23)
    v_mfma_f32_32x32x16_bf16 v[76:91], v[36:39], v[168:171], 0
    v_mfma_f32_32x32x16_bf16 v[76:91], v[44:47], v[172:175], v[76:91]
    v_mfma_f32_32x32x16_bf16 v[76:91], v[52:55], v[176:179], v[76:91]
    v_mfma_f32_32x32x16_bf16 v[76:91], v[160:163], v[180:183], v[76:91]
    v_mfma_f32_32x32x16_bf16 v[92:107], v[40:43], v[168:171], 0
    v_mfma_f32_32x32x16_bf16 v[92:107], v[48:51], v[172:175], v[92:107]
    v_mfma_f32_32x32x16_bf16 v[92:107], v[56:59], v[176:179], v[92:107]
    v_mfma_f32_32x32x16_bf16 v[92:107], v[164:167], v[180:183], v[92:107]
    s_waitcnt vmcnt(11)
    v_mfma_f32_32x32x16_bf16 v[76:91], v[4:7], v[140:143], v[76:91]
    v_mfma_f32_32x32x16_bf16 v[76:91], v[12:15], v[144:147], v[76:91]
    v_mfma_f32_32x32x16_bf16 v[76:91], v[20:23], v[148:151], v[76:91]
    v_mfma_f32_32x32x16_bf16 v[76:91], v[28:31], v[152:155], v[76:91]
    v_mfma_f32_32x32x16_bf16 v[92:107], v[8:11], v[140:143], v[92:107]
    v_mfma_f32_32x32x16_bf16 v[92:107], v[16:19], v[144:147], v[92:107]
    v_mfma_f32_32x32x16_bf16 v[92:107], v[24:27], v[148:151], v[92:107]
    v_mfma_f32_32x32x16_bf16 v[92:107], v[32:35], v[152:155], v[92:107]
    s_nop 15
    v_cvt_pk_bf16_f32 v204, v76, v77
    v_lshlrev_b32 v76, 16, v204
    v_and_b32 v77, s54, v204
    v_cvt_pk_bf16_f32 v204, v78, v79
    v_lshlrev_b32 v78, 16, v204
    v_and_b32 v79, s54, v204
    v_cvt_pk_bf16_f32 v204, v80, v81
    v_lshlrev_b32 v80, 16, v204
    v_and_b32 v81, s54, v204
    v_cvt_pk_bf16_f32 v204, v82, v83
    v_lshlrev_b32 v82, 16, v204
    v_and_b32 v83, s54, v204
    v_cvt_pk_bf16_f32 v204, v84, v85
    v_lshlrev_b32 v84, 16, v204
    v_and_b32 v85, s54, v204
    v_cvt_pk_bf16_f32 v204, v86, v87
    v_lshlrev_b32 v86, 16, v204
    v_and_b32 v87, s54, v204
    v_cvt_pk_bf16_f32 v204, v88, v89
    v_lshlrev_b32 v88, 16, v204
    v_and_b32 v89, s54, v204
    v_cvt_pk_bf16_f32 v204, v90, v91
    v_lshlrev_b32 v90, 16, v204
    v_and_b32 v91, s54, v204
    v_cvt_pk_bf16_f32 v204, v92, v93
    v_lshlrev_b32 v92, 16, v204
    v_and_b32 v93, s54, v204
    v_cvt_pk_bf16_f32 v204, v94, v95
    v_lshlrev_b32 v94, 16, v204
    v_and_b32 v95, s54, v204
    v_cvt_pk_bf16_f32 v204, v96, v97
    v_lshlrev_b32 v96, 16, v204
    v_and_b32 v97, s54, v204
    v_cvt_pk_bf16_f32 v204, v98, v99
    v_lshlrev_b32 v98, 16, v204
    v_and_b32 v99, s54, v204
    v_cvt_pk_bf16_f32 v204, v100, v101
    v_lshlrev_b32 v100, 16, v204
    v_and_b32 v101, s54, v204
    v_cvt_pk_bf16_f32 v204, v102, v103
    v_lshlrev_b32 v102, 16, v204
    v_and_b32 v103, s54, v204
    v_cvt_pk_bf16_f32 v204, v104, v105
    v_lshlrev_b32 v104, 16, v204
    v_and_b32 v105, s54, v204
    v_cvt_pk_bf16_f32 v204, v106, v107
    v_lshlrev_b32 v106, 16, v204
    v_and_b32 v107, s54, v204
    s_mov_b32 s3, 0xbfb8aa3b
    v_pk_mul_f32 v[204:205], s[84:85], v[76:77]
    v_pk_mul_f32 v[206:207], s[84:85], v[78:79]
    v_pk_mul_f32 v[208:209], s[84:85], v[80:81]
    v_pk_mul_f32 v[210:211], s[84:85], v[82:83]
    v_exp_f32 v204, v204
    v_exp_f32 v205, v205
    v_exp_f32 v206, v206
    v_exp_f32 v207, v207
    v_exp_f32 v208, v208
    v_exp_f32 v209, v209
    v_exp_f32 v210, v210
    v_exp_f32 v211, v211
    v_pk_add_f32 v[204:205], s[86:87], v[204:205]
    v_pk_add_f32 v[206:207], s[86:87], v[206:207]
    v_pk_add_f32 v[208:209], s[86:87], v[208:209]
    v_pk_add_f32 v[210:211], s[86:87], v[210:211]
    v_rcp_f32 v204, v204
    v_rcp_f32 v205, v205
    v_rcp_f32 v206, v206
    v_rcp_f32 v207, v207
    v_rcp_f32 v208, v208
    v_rcp_f32 v209, v209
    v_rcp_f32 v210, v210
    v_rcp_f32 v211, v211
    v_pk_mul_f32 v[76:77], v[76:77], v[204:205]
    v_pk_mul_f32 v[78:79], v[78:79], v[206:207]
    v_pk_mul_f32 v[80:81], v[80:81], v[208:209]
    v_pk_mul_f32 v[82:83], v[82:83], v[210:211]
    v_pk_mul_f32 v[204:205], s[84:85], v[84:85]
    v_pk_mul_f32 v[206:207], s[84:85], v[86:87]
    v_pk_mul_f32 v[208:209], s[84:85], v[88:89]
    v_pk_mul_f32 v[210:211], s[84:85], v[90:91]
    v_exp_f32 v204, v204
    v_exp_f32 v205, v205
    v_exp_f32 v206, v206
    v_exp_f32 v207, v207
    v_exp_f32 v208, v208
    v_exp_f32 v209, v209
    v_exp_f32 v210, v210
    v_exp_f32 v211, v211
    v_pk_add_f32 v[204:205], s[86:87], v[204:205]
    v_pk_add_f32 v[206:207], s[86:87], v[206:207]
    v_pk_add_f32 v[208:209], s[86:87], v[208:209]
    v_pk_add_f32 v[210:211], s[86:87], v[210:211]
    v_rcp_f32 v204, v204
    v_rcp_f32 v205, v205
    v_rcp_f32 v206, v206
    v_rcp_f32 v207, v207
    v_rcp_f32 v208, v208
    v_rcp_f32 v209, v209
    v_rcp_f32 v210, v210
    v_rcp_f32 v211, v211
    v_pk_mul_f32 v[84:85], v[84:85], v[204:205]
    v_pk_mul_f32 v[86:87], v[86:87], v[206:207]
    v_pk_mul_f32 v[88:89], v[88:89], v[208:209]
    v_pk_mul_f32 v[90:91], v[90:91], v[210:211]
    v_pk_mul_f32 v[204:205], s[84:85], v[92:93]
    v_pk_mul_f32 v[206:207], s[84:85], v[94:95]
    v_pk_mul_f32 v[208:209], s[84:85], v[96:97]
    v_pk_mul_f32 v[210:211], s[84:85], v[98:99]
    v_exp_f32 v204, v204
    v_exp_f32 v205, v205
    v_exp_f32 v206, v206
    v_exp_f32 v207, v207
    v_exp_f32 v208, v208
    v_exp_f32 v209, v209
    v_exp_f32 v210, v210
    v_exp_f32 v211, v211
    v_pk_add_f32 v[204:205], s[86:87], v[204:205]
    v_pk_add_f32 v[206:207], s[86:87], v[206:207]
    v_pk_add_f32 v[208:209], s[86:87], v[208:209]
    v_pk_add_f32 v[210:211], s[86:87], v[210:211]
    v_rcp_f32 v204, v204
    v_rcp_f32 v205, v205
    v_rcp_f32 v206, v206
    v_rcp_f32 v207, v207
    v_rcp_f32 v208, v208
    v_rcp_f32 v209, v209
    v_rcp_f32 v210, v210
    v_rcp_f32 v211, v211
    v_pk_mul_f32 v[92:93], v[92:93], v[204:205]
    v_pk_mul_f32 v[94:95], v[94:95], v[206:207]
    v_pk_mul_f32 v[96:97], v[96:97], v[208:209]
    v_pk_mul_f32 v[98:99], v[98:99], v[210:211]
    v_pk_mul_f32 v[204:205], s[84:85], v[100:101]
    v_pk_mul_f32 v[206:207], s[84:85], v[102:103]
    v_pk_mul_f32 v[208:209], s[84:85], v[104:105]
    v_pk_mul_f32 v[210:211], s[84:85], v[106:107]
    v_exp_f32 v204, v204
    v_exp_f32 v205, v205
    v_exp_f32 v206, v206
    v_exp_f32 v207, v207
    v_exp_f32 v208, v208
    v_exp_f32 v209, v209
    v_exp_f32 v210, v210
    v_exp_f32 v211, v211
    v_pk_add_f32 v[204:205], s[86:87], v[204:205]
    v_pk_add_f32 v[206:207], s[86:87], v[206:207]
    v_pk_add_f32 v[208:209], s[86:87], v[208:209]
    v_pk_add_f32 v[210:211], s[86:87], v[210:211]
    v_rcp_f32 v204, v204
    v_rcp_f32 v205, v205
    v_rcp_f32 v206, v206
    v_rcp_f32 v207, v207
    v_rcp_f32 v208, v208
    v_rcp_f32 v209, v209
    v_rcp_f32 v210, v210
    v_rcp_f32 v211, v211
    v_pk_mul_f32 v[100:101], v[100:101], v[204:205]
    v_pk_mul_f32 v[102:103], v[102:103], v[206:207]
    v_pk_mul_f32 v[104:105], v[104:105], v[208:209]
    v_pk_mul_f32 v[106:107], v[106:107], v[210:211]
    s_waitcnt vmcnt(3)
    v_cvt_pk_bf16_f32 v204, v76, v77
    v_lshlrev_b32 v76, 16, v204
    v_and_b32 v77, s54, v204
    v_lshlrev_b32 v206, 16, v184
    v_and_b32 v207, s54, v184
    v_pk_add_f32 v[76:77], v[76:77], v[206:207]
    v_cvt_pk_bf16_f32 v168, v76, v77
    v_cvt_pk_bf16_f32 v204, v78, v79
    v_lshlrev_b32 v78, 16, v204
    v_and_b32 v79, s54, v204
    v_lshlrev_b32 v206, 16, v185
    v_and_b32 v207, s54, v185
    v_pk_add_f32 v[78:79], v[78:79], v[206:207]
    v_cvt_pk_bf16_f32 v169, v78, v79
    ds_write_b64 v60, v[168:169]
    v_cvt_pk_bf16_f32 v204, v80, v81
    v_lshlrev_b32 v80, 16, v204
    v_and_b32 v81, s54, v204
    v_lshlrev_b32 v206, 16, v186
    v_and_b32 v207, s54, v186
    v_pk_add_f32 v[80:81], v[80:81], v[206:207]
    v_cvt_pk_bf16_f32 v170, v80, v81
    v_cvt_pk_bf16_f32 v204, v82, v83
    v_lshlrev_b32 v82, 16, v204
    v_and_b32 v83, s54, v204
    v_lshlrev_b32 v206, 16, v187
    v_and_b32 v207, s54, v187
    v_pk_add_f32 v[82:83], v[82:83], v[206:207]
    v_cvt_pk_bf16_f32 v171, v82, v83
    ds_write_b64 v61, v[170:171]
    v_cvt_pk_bf16_f32 v204, v84, v85
    v_lshlrev_b32 v84, 16, v204
    v_and_b32 v85, s54, v204
    v_lshlrev_b32 v206, 16, v188
    v_and_b32 v207, s54, v188
    v_pk_add_f32 v[84:85], v[84:85], v[206:207]
    v_cvt_pk_bf16_f32 v172, v84, v85
    v_cvt_pk_bf16_f32 v204, v86, v87
    v_lshlrev_b32 v86, 16, v204
    v_and_b32 v87, s54, v204
    v_lshlrev_b32 v206, 16, v189
    v_and_b32 v207, s54, v189
    v_pk_add_f32 v[86:87], v[86:87], v[206:207]
    v_cvt_pk_bf16_f32 v173, v86, v87
    ds_write_b64 v62, v[172:173]
    v_cvt_pk_bf16_f32 v204, v88, v89
    v_lshlrev_b32 v88, 16, v204
    v_and_b32 v89, s54, v204
    v_lshlrev_b32 v206, 16, v190
    v_and_b32 v207, s54, v190
    v_pk_add_f32 v[88:89], v[88:89], v[206:207]
    v_cvt_pk_bf16_f32 v174, v88, v89
    v_cvt_pk_bf16_f32 v204, v90, v91
    v_lshlrev_b32 v90, 16, v204
    v_and_b32 v91, s54, v204
    v_lshlrev_b32 v206, 16, v191
    v_and_b32 v207, s54, v191
    v_pk_add_f32 v[90:91], v[90:91], v[206:207]
    v_cvt_pk_bf16_f32 v175, v90, v91
    ds_write_b64 v63, v[174:175]
    v_cvt_pk_bf16_f32 v204, v92, v93
    v_lshlrev_b32 v92, 16, v204
    v_and_b32 v93, s54, v204
    v_lshlrev_b32 v206, 16, v192
    v_and_b32 v207, s54, v192
    v_pk_add_f32 v[92:93], v[92:93], v[206:207]
    v_cvt_pk_bf16_f32 v176, v92, v93
    v_cvt_pk_bf16_f32 v204, v94, v95
    v_lshlrev_b32 v94, 16, v204
    v_and_b32 v95, s54, v204
    v_lshlrev_b32 v206, 16, v193
    v_and_b32 v207, s54, v193
    v_pk_add_f32 v[94:95], v[94:95], v[206:207]
    v_cvt_pk_bf16_f32 v177, v94, v95
    ds_write_b64 v64, v[176:177]
    v_cvt_pk_bf16_f32 v204, v96, v97
    v_lshlrev_b32 v96, 16, v204
    v_and_b32 v97, s54, v204
    v_lshlrev_b32 v206, 16, v194
    v_and_b32 v207, s54, v194
    v_pk_add_f32 v[96:97], v[96:97], v[206:207]
    v_cvt_pk_bf16_f32 v178, v96, v97
    v_cvt_pk_bf16_f32 v204, v98, v99
    v_lshlrev_b32 v98, 16, v204
    v_and_b32 v99, s54, v204
    v_lshlrev_b32 v206, 16, v195
    v_and_b32 v207, s54, v195
    v_pk_add_f32 v[98:99], v[98:99], v[206:207]
    v_cvt_pk_bf16_f32 v179, v98, v99
    ds_write_b64 v65, v[178:179]
    v_cvt_pk_bf16_f32 v204, v100, v101
    v_lshlrev_b32 v100, 16, v204
    v_and_b32 v101, s54, v204
    v_lshlrev_b32 v206, 16, v196
    v_and_b32 v207, s54, v196
    v_pk_add_f32 v[100:101], v[100:101], v[206:207]
    v_cvt_pk_bf16_f32 v180, v100, v101
    v_cvt_pk_bf16_f32 v204, v102, v103
    v_lshlrev_b32 v102, 16, v204
    v_and_b32 v103, s54, v204
    v_lshlrev_b32 v206, 16, v197
    v_and_b32 v207, s54, v197
    v_pk_add_f32 v[102:103], v[102:103], v[206:207]
    v_cvt_pk_bf16_f32 v181, v102, v103
    ds_write_b64 v66, v[180:181]
    v_cvt_pk_bf16_f32 v204, v104, v105
    v_lshlrev_b32 v104, 16, v204
    v_and_b32 v105, s54, v204
    v_lshlrev_b32 v206, 16, v198
    v_and_b32 v207, s54, v198
    v_pk_add_f32 v[104:105], v[104:105], v[206:207]
    v_cvt_pk_bf16_f32 v182, v104, v105
    v_cvt_pk_bf16_f32 v204, v106, v107
    v_lshlrev_b32 v106, 16, v204
    v_and_b32 v107, s54, v204
    v_lshlrev_b32 v206, 16, v199
    v_and_b32 v207, s54, v199
    v_pk_add_f32 v[106:107], v[106:107], v[206:207]
    v_cvt_pk_bf16_f32 v183, v106, v107
    ds_write_b64 v67, v[182:183]
    ds_read_b128 v[108:111], v69 offset:0
    ds_read_b128 v[112:115], v69 offset:1024
    ds_read_b128 v[116:119], v69 offset:2048
    ds_read_b128 v[120:123], v69 offset:3072
    s_waitcnt lgkmcnt(3)
    buffer_store_dwordx4 v[108:111], v70, s[32:35], 0 offen offset:0 sc1
    s_waitcnt lgkmcnt(2)
    buffer_store_dwordx4 v[112:115], v71, s[32:35], 0 offen offset:1024 sc1
    s_waitcnt lgkmcnt(1)
    buffer_store_dwordx4 v[116:119], v70, s[32:35], 0 offen offset:2048 sc1
    s_mov_b64 exec, 0xff
    s_waitcnt lgkmcnt(0)
    buffer_store_dwordx4 v[120:123], v71, s[32:35], 0 offen offset:3072 sc1
    s_branch LM_fin
LM_epif:
    v_and_b32 v220, 31, v0
    v_bfe_u32 v221, v0, 5, 1
    v_add_u32 v213, s46, v220
    v_lshlrev_b32 v214, 7, v213
    v_lshl_add_u32 v214, v221, 3, v214
    s_add_u32 s27, s27, s47
    v_lshrrev_b32 v224, 3, v220
    v_and_b32 v222, 7, v220
    v_lshl_add_u32 v215, v224, 10, s27
    v_lshl_add_u32 v215, v222, 7, v215
    v_lshl_add_u32 v215, v221, 3, v215
    v_and_b32 v224, 1, v224
    v_xor_b32 v224, v224, v222
    v_lshl_add_u32 v215, v224, 4, v215
    v_xor_b32 v60, 0, v215
    v_xor_b32 v61, 16, v215
    v_xor_b32 v62, 32, v215
    v_xor_b32 v63, 48, v215
    v_xor_b32 v64, 64, v215
    v_xor_b32 v65, 80, v215
    v_xor_b32 v66, 96, v215
    v_xor_b32 v67, 112, v215
    ds_read_b64 v[184:185], v60
    ds_read_b64 v[186:187], v61
    ds_read_b64 v[188:189], v62
    ds_read_b64 v[190:191], v63
    ds_read_b64 v[192:193], v64
    ds_read_b64 v[194:195], v65
    ds_read_b64 v[196:197], v66
    ds_read_b64 v[198:199], v67
    v_and_b32 v68, 63, v0
    v_lshl_add_u32 v69, v68, 4, s27
    v_lshrrev_b32 v68, 3, v68
    v_add_u32 v68, s46, v68
    v_lshl_add_u32 v70, v68, 7, v240
    v_lshl_add_u32 v71, v68, 7, v241
    s_mov_b32 s82, s56
    s_mov_b32 s83, s56
    s_mov_b32 s84, 0xbfb8aa3b
    s_mov_b32 s85, 0xbfb8aa3b
    s_mov_b32 s86, 1.0
    s_mov_b32 s87, 1.0
    s_waitcnt vmcnt(0)
    v_mfma_f32_32x32x16_bf16 v[76:91], v[4:7], v[140:143], 0
    v_pk_mul_f32 v[108:109], s[82:83], v[108:109]
    v_pk_mul_f32 v[110:111], s[82:83], v[110:111]
    v_mfma_f32_32x32x16_bf16 v[92:107], v[8:11], v[140:143], 0
    v_pk_mul_f32 v[112:113], s[82:83], v[112:113]
    v_pk_mul_f32 v[114:115], s[82:83], v[114:115]
    v_mfma_f32_32x32x16_bf16 v[76:91], v[12:15], v[144:147], v[76:91]
    v_pk_mul_f32 v[116:117], s[82:83], v[116:117]
    v_pk_mul_f32 v[118:119], s[82:83], v[118:119]
    v_mfma_f32_32x32x16_bf16 v[92:107], v[16:19], v[144:147], v[92:107]
    v_pk_mul_f32 v[120:121], s[82:83], v[120:121]
    v_pk_mul_f32 v[122:123], s[82:83], v[122:123]
    v_mfma_f32_32x32x16_bf16 v[76:91], v[20:23], v[148:151], v[76:91]
    v_pk_mul_f32 v[124:125], s[82:83], v[124:125]
    v_pk_mul_f32 v[126:127], s[82:83], v[126:127]
    v_mfma_f32_32x32x16_bf16 v[92:107], v[24:27], v[148:151], v[92:107]
    v_pk_mul_f32 v[128:129], s[82:83], v[128:129]
    v_pk_mul_f32 v[130:131], s[82:83], v[130:131]
    v_mfma_f32_32x32x16_bf16 v[76:91], v[28:31], v[152:155], v[76:91]
    v_pk_mul_f32 v[132:133], s[82:83], v[132:133]
    v_pk_mul_f32 v[134:135], s[82:83], v[134:135]
    v_mfma_f32_32x32x16_bf16 v[92:107], v[32:35], v[152:155], v[92:107]
    v_pk_mul_f32 v[136:137], s[82:83], v[136:137]
    v_pk_mul_f32 v[138:139], s[82:83], v[138:139]
    v_cvt_pk_bf16_f32 v168, v108, v109
    v_cvt_pk_bf16_f32 v169, v110, v111
    v_cvt_pk_bf16_f32 v170, v112, v113
    v_cvt_pk_bf16_f32 v171, v114, v115
    v_cvt_pk_bf16_f32 v172, v116, v117
    v_cvt_pk_bf16_f32 v173, v118, v119
    v_cvt_pk_bf16_f32 v174, v120, v121
    v_cvt_pk_bf16_f32 v175, v122, v123
    v_cvt_pk_bf16_f32 v176, v124, v125
    v_cvt_pk_bf16_f32 v177, v126, v127
    v_cvt_pk_bf16_f32 v178, v128, v129
    v_cvt_pk_bf16_f32 v179, v130, v131
    v_cvt_pk_bf16_f32 v180, v132, v133
    v_cvt_pk_bf16_f32 v181, v134, v135
    v_cvt_pk_bf16_f32 v182, v136, v137
    v_cvt_pk_bf16_f32 v183, v138, v139
    s_nop 0
    v_mfma_f32_32x32x16_bf16 v[76:91], v[36:39], v[168:171], v[76:91]
    v_mfma_f32_32x32x16_bf16 v[92:107], v[40:43], v[168:171], v[92:107]
    v_mfma_f32_32x32x16_bf16 v[76:91], v[44:47], v[172:175], v[76:91]
    v_mfma_f32_32x32x16_bf16 v[92:107], v[48:51], v[172:175], v[92:107]
    v_mfma_f32_32x32x16_bf16 v[76:91], v[52:55], v[176:179], v[76:91]
    v_mfma_f32_32x32x16_bf16 v[92:107], v[56:59], v[176:179], v[92:107]
    v_mfma_f32_32x32x16_bf16 v[76:91], v[160:163], v[180:183], v[76:91]
    v_mfma_f32_32x32x16_bf16 v[92:107], v[164:167], v[180:183], v[92:107]
    s_mov_b64 exec, 0x01ffffff
    v_lshl_add_u32 v224, v220, 4, s59
    ds_read_b96 v[208:210], v224
    v_mul_u32_u24 v215, 6, v213
    v_add_u32 v215, 6400000, v215
    v_cvt_pk_bf16_f32 v200, v216, v217
    v_cvt_pk_bf16_f32 v201, v218, v218
    v_lshlrev_b32 v204, 16, v200
    v_and_b32 v205, s54, v200
    v_lshlrev_b32 v206, 16, v201
    s_waitcnt lgkmcnt(0)
    v_add_f32 v204, v204, v208
    v_add_f32 v205, v205, v209
    v_add_f32 v206, v206, v210
    v_cvt_pk_bf16_f32 v200, v204, v204
    v_cvt_pk_bf16_f32 v201, v205, v205
    v_cvt_pk_bf16_f32 v202, v206, v206
    buffer_store_short v200, v215, s[32:35], 0 offen offset:0 sc1
    buffer_store_short v201, v215, s[32:35], 0 offen offset:2 sc1
    buffer_store_short v202, v215, s[32:35], 0 offen offset:4 sc1
    s_mov_b64 exec, -1
    v_lshlrev_b32 v108, 16, v184
    v_and_b32 v109, s54, v184
    v_lshlrev_b32 v110, 16, v185
    v_and_b32 v111, s54, v185
    v_lshlrev_b32 v112, 16, v186
    v_and_b32 v113, s54, v186
    v_lshlrev_b32 v114, 16, v187
    v_and_b32 v115, s54, v187
    v_lshlrev_b32 v116, 16, v188
    v_and_b32 v117, s54, v188
    v_lshlrev_b32 v118, 16, v189
    v_and_b32 v119, s54, v189
    v_lshlrev_b32 v120, 16, v190
    v_and_b32 v121, s54, v190
    v_lshlrev_b32 v122, 16, v191
    v_and_b32 v123, s54, v191
    v_lshlrev_b32 v124, 16, v192
    v_and_b32 v125, s54, v192
    v_lshlrev_b32 v126, 16, v193
    v_and_b32 v127, s54, v193
    v_lshlrev_b32 v128, 16, v194
    v_and_b32 v129, s54, v194
    v_lshlrev_b32 v130, 16, v195
    v_and_b32 v131, s54, v195
    v_lshlrev_b32 v132, 16, v196
    v_and_b32 v133, s54, v196
    v_lshlrev_b32 v134, 16, v197
    v_and_b32 v135, s54, v197
    v_lshlrev_b32 v136, 16, v198
    v_and_b32 v137, s54, v198
    v_lshlrev_b32 v138, 16, v199
    v_and_b32 v139, s54, v199
    v_cvt_pk_bf16_f32 v204, v76, v77
    v_lshlrev_b32 v76, 16, v204
    v_and_b32 v77, s54, v204
    v_cvt_pk_bf16_f32 v204, v78, v79
    v_lshlrev_b32 v78, 16, v204
    v_and_b32 v79, s54, v204
    v_cvt_pk_bf16_f32 v204, v80, v81
    v_lshlrev_b32 v80, 16, v204
    v_and_b32 v81, s54, v204
    v_cvt_pk_bf16_f32 v204, v82, v83
    v_lshlrev_b32 v82, 16, v204
    v_and_b32 v83, s54, v204
    v_cvt_pk_bf16_f32 v204, v84, v85
    v_lshlrev_b32 v84, 16, v204
    v_and_b32 v85, s54, v204
    v_cvt_pk_bf16_f32 v204, v86, v87
    v_lshlrev_b32 v86, 16, v204
    v_and_b32 v87, s54, v204
    v_cvt_pk_bf16_f32 v204, v88, v89
    v_lshlrev_b32 v88, 16, v204
    v_and_b32 v89, s54, v204
    v_cvt_pk_bf16_f32 v204, v90, v91
    v_lshlrev_b32 v90, 16, v204
    v_and_b32 v91, s54, v204
    v_cvt_pk_bf16_f32 v204, v92, v93
    v_lshlrev_b32 v92, 16, v204
    v_and_b32 v93, s54, v204
    v_cvt_pk_bf16_f32 v204, v94, v95
    v_lshlrev_b32 v94, 16, v204
    v_and_b32 v95, s54, v204
    v_cvt_pk_bf16_f32 v204, v96, v97
    v_lshlrev_b32 v96, 16, v204
    v_and_b32 v97, s54, v204
    v_cvt_pk_bf16_f32 v204, v98, v99
    v_lshlrev_b32 v98, 16, v204
    v_and_b32 v99, s54, v204
    v_cvt_pk_bf16_f32 v204, v100, v101
    v_lshlrev_b32 v100, 16, v204
    v_and_b32 v101, s54, v204
    v_cvt_pk_bf16_f32 v204, v102, v103
    v_lshlrev_b32 v102, 16, v204
    v_and_b32 v103, s54, v204
    v_cvt_pk_bf16_f32 v204, v104, v105
    v_lshlrev_b32 v104, 16, v204
    v_and_b32 v105, s54, v204
    v_cvt_pk_bf16_f32 v204, v106, v107
    v_lshlrev_b32 v106, 16, v204
    v_and_b32 v107, s54, v204
    s_mov_b32 s3, 0xbfb8aa3b
    v_pk_mul_f32 v[204:205], s[84:85], v[76:77]
    v_pk_mul_f32 v[206:207], s[84:85], v[78:79]
    v_pk_mul_f32 v[208:209], s[84:85], v[80:81]
    v_pk_mul_f32 v[210:211], s[84:85], v[82:83]
    v_exp_f32 v204, v204
    v_exp_f32 v205, v205
    v_exp_f32 v206, v206
    v_exp_f32 v207, v207
    v_exp_f32 v208, v208
    v_exp_f32 v209, v209
    v_exp_f32 v210, v210
    v_exp_f32 v211, v211
    v_pk_add_f32 v[204:205], s[86:87], v[204:205]
    v_pk_add_f32 v[206:207], s[86:87], v[206:207]
    v_pk_add_f32 v[208:209], s[86:87], v[208:209]
    v_pk_add_f32 v[210:211], s[86:87], v[210:211]
    v_rcp_f32 v204, v204
    v_rcp_f32 v205, v205
    v_rcp_f32 v206, v206
    v_rcp_f32 v207, v207
    v_rcp_f32 v208, v208
    v_rcp_f32 v209, v209
    v_rcp_f32 v210, v210
    v_rcp_f32 v211, v211
    v_pk_mul_f32 v[76:77], v[76:77], v[204:205]
    v_pk_mul_f32 v[78:79], v[78:79], v[206:207]
    v_pk_mul_f32 v[80:81], v[80:81], v[208:209]
    v_pk_mul_f32 v[82:83], v[82:83], v[210:211]
    v_pk_mul_f32 v[204:205], s[84:85], v[84:85]
    v_pk_mul_f32 v[206:207], s[84:85], v[86:87]
    v_pk_mul_f32 v[208:209], s[84:85], v[88:89]
    v_pk_mul_f32 v[210:211], s[84:85], v[90:91]
    v_exp_f32 v204, v204
    v_exp_f32 v205, v205
    v_exp_f32 v206, v206
    v_exp_f32 v207, v207
    v_exp_f32 v208, v208
    v_exp_f32 v209, v209
    v_exp_f32 v210, v210
    v_exp_f32 v211, v211
    v_pk_add_f32 v[204:205], s[86:87], v[204:205]
    v_pk_add_f32 v[206:207], s[86:87], v[206:207]
    v_pk_add_f32 v[208:209], s[86:87], v[208:209]
    v_pk_add_f32 v[210:211], s[86:87], v[210:211]
    v_rcp_f32 v204, v204
    v_rcp_f32 v205, v205
    v_rcp_f32 v206, v206
    v_rcp_f32 v207, v207
    v_rcp_f32 v208, v208
    v_rcp_f32 v209, v209
    v_rcp_f32 v210, v210
    v_rcp_f32 v211, v211
    v_pk_mul_f32 v[84:85], v[84:85], v[204:205]
    v_pk_mul_f32 v[86:87], v[86:87], v[206:207]
    v_pk_mul_f32 v[88:89], v[88:89], v[208:209]
    v_pk_mul_f32 v[90:91], v[90:91], v[210:211]
    v_pk_mul_f32 v[204:205], s[84:85], v[92:93]
    v_pk_mul_f32 v[206:207], s[84:85], v[94:95]
    v_pk_mul_f32 v[208:209], s[84:85], v[96:97]
    v_pk_mul_f32 v[210:211], s[84:85], v[98:99]
    v_exp_f32 v204, v204
    v_exp_f32 v205, v205
    v_exp_f32 v206, v206
    v_exp_f32 v207, v207
    v_exp_f32 v208, v208
    v_exp_f32 v209, v209
    v_exp_f32 v210, v210
    v_exp_f32 v211, v211
    v_pk_add_f32 v[204:205], s[86:87], v[204:205]
    v_pk_add_f32 v[206:207], s[86:87], v[206:207]
    v_pk_add_f32 v[208:209], s[86:87], v[208:209]
    v_pk_add_f32 v[210:211], s[86:87], v[210:211]
    v_rcp_f32 v204, v204
    v_rcp_f32 v205, v205
    v_rcp_f32 v206, v206
    v_rcp_f32 v207, v207
    v_rcp_f32 v208, v208
    v_rcp_f32 v209, v209
    v_rcp_f32 v210, v210
    v_rcp_f32 v211, v211
    v_pk_mul_f32 v[92:93], v[92:93], v[204:205]
    v_pk_mul_f32 v[94:95], v[94:95], v[206:207]
    v_pk_mul_f32 v[96:97], v[96:97], v[208:209]
    v_pk_mul_f32 v[98:99], v[98:99], v[210:211]
    v_pk_mul_f32 v[204:205], s[84:85], v[100:101]
    v_pk_mul_f32 v[206:207], s[84:85], v[102:103]
    v_pk_mul_f32 v[208:209], s[84:85], v[104:105]
    v_pk_mul_f32 v[210:211], s[84:85], v[106:107]
    v_exp_f32 v204, v204
    v_exp_f32 v205, v205
    v_exp_f32 v206, v206
    v_exp_f32 v207, v207
    v_exp_f32 v208, v208
    v_exp_f32 v209, v209
    v_exp_f32 v210, v210
    v_exp_f32 v211, v211
    v_pk_add_f32 v[204:205], s[86:87], v[204:205]
    v_pk_add_f32 v[206:207], s[86:87], v[206:207]
    v_pk_add_f32 v[208:209], s[86:87], v[208:209]
    v_pk_add_f32 v[210:211], s[86:87], v[210:211]
    v_rcp_f32 v204, v204
    v_rcp_f32 v205, v205
    v_rcp_f32 v206, v206
    v_rcp_f32 v207, v207
    v_rcp_f32 v208, v208
    v_rcp_f32 v209, v209
    v_rcp_f32 v210, v210
    v_rcp_f32 v211, v211
    v_pk_mul_f32 v[100:101], v[100:101], v[204:205]
    v_pk_mul_f32 v[102:103], v[102:103], v[206:207]
    v_pk_mul_f32 v[104:105], v[104:105], v[208:209]
    v_pk_mul_f32 v[106:107], v[106:107], v[210:211]
    v_cvt_pk_bf16_f32 v204, v76, v77
    v_lshlrev_b32 v76, 16, v204
    v_and_b32 v77, s54, v204
    v_pk_add_f32 v[76:77], v[76:77], v[108:109]
    v_cvt_pk_bf16_f32 v168, v76, v77
    v_cvt_pk_bf16_f32 v204, v78, v79
    v_lshlrev_b32 v78, 16, v204
    v_and_b32 v79, s54, v204
    v_pk_add_f32 v[78:79], v[78:79], v[110:111]
    v_cvt_pk_bf16_f32 v169, v78, v79
    ds_write_b64 v60, v[168:169]
    v_cvt_pk_bf16_f32 v204, v80, v81
    v_lshlrev_b32 v80, 16, v204
    v_and_b32 v81, s54, v204
    v_pk_add_f32 v[80:81], v[80:81], v[112:113]
    v_cvt_pk_bf16_f32 v170, v80, v81
    v_cvt_pk_bf16_f32 v204, v82, v83
    v_lshlrev_b32 v82, 16, v204
    v_and_b32 v83, s54, v204
    v_pk_add_f32 v[82:83], v[82:83], v[114:115]
    v_cvt_pk_bf16_f32 v171, v82, v83
    ds_write_b64 v61, v[170:171]
    v_cvt_pk_bf16_f32 v204, v84, v85
    v_lshlrev_b32 v84, 16, v204
    v_and_b32 v85, s54, v204
    v_pk_add_f32 v[84:85], v[84:85], v[116:117]
    v_cvt_pk_bf16_f32 v172, v84, v85
    v_cvt_pk_bf16_f32 v204, v86, v87
    v_lshlrev_b32 v86, 16, v204
    v_and_b32 v87, s54, v204
    v_pk_add_f32 v[86:87], v[86:87], v[118:119]
    v_cvt_pk_bf16_f32 v173, v86, v87
    ds_write_b64 v62, v[172:173]
    v_cvt_pk_bf16_f32 v204, v88, v89
    v_lshlrev_b32 v88, 16, v204
    v_and_b32 v89, s54, v204
    v_pk_add_f32 v[88:89], v[88:89], v[120:121]
    v_cvt_pk_bf16_f32 v174, v88, v89
    v_cvt_pk_bf16_f32 v204, v90, v91
    v_lshlrev_b32 v90, 16, v204
    v_and_b32 v91, s54, v204
    v_pk_add_f32 v[90:91], v[90:91], v[122:123]
    v_cvt_pk_bf16_f32 v175, v90, v91
    ds_write_b64 v63, v[174:175]
    v_cvt_pk_bf16_f32 v204, v92, v93
    v_lshlrev_b32 v92, 16, v204
    v_and_b32 v93, s54, v204
    v_pk_add_f32 v[92:93], v[92:93], v[124:125]
    v_cvt_pk_bf16_f32 v176, v92, v93
    v_cvt_pk_bf16_f32 v204, v94, v95
    v_lshlrev_b32 v94, 16, v204
    v_and_b32 v95, s54, v204
    v_pk_add_f32 v[94:95], v[94:95], v[126:127]
    v_cvt_pk_bf16_f32 v177, v94, v95
    ds_write_b64 v64, v[176:177]
    v_cvt_pk_bf16_f32 v204, v96, v97
    v_lshlrev_b32 v96, 16, v204
    v_and_b32 v97, s54, v204
    v_pk_add_f32 v[96:97], v[96:97], v[128:129]
    v_cvt_pk_bf16_f32 v178, v96, v97
    v_cvt_pk_bf16_f32 v204, v98, v99
    v_lshlrev_b32 v98, 16, v204
    v_and_b32 v99, s54, v204
    v_pk_add_f32 v[98:99], v[98:99], v[130:131]
    v_cvt_pk_bf16_f32 v179, v98, v99
    ds_write_b64 v65, v[178:179]
    v_cvt_pk_bf16_f32 v204, v100, v101
    v_lshlrev_b32 v100, 16, v204
    v_and_b32 v101, s54, v204
    v_pk_add_f32 v[100:101], v[100:101], v[132:133]
    v_cvt_pk_bf16_f32 v180, v100, v101
    v_cvt_pk_bf16_f32 v204, v102, v103
    v_lshlrev_b32 v102, 16, v204
    v_and_b32 v103, s54, v204
    v_pk_add_f32 v[102:103], v[102:103], v[134:135]
    v_cvt_pk_bf16_f32 v181, v102, v103
    ds_write_b64 v66, v[180:181]
    v_cvt_pk_bf16_f32 v204, v104, v105
    v_lshlrev_b32 v104, 16, v204
    v_and_b32 v105, s54, v204
    v_pk_add_f32 v[104:105], v[104:105], v[136:137]
    v_cvt_pk_bf16_f32 v182, v104, v105
    v_cvt_pk_bf16_f32 v204, v106, v107
    v_lshlrev_b32 v106, 16, v204
    v_and_b32 v107, s54, v204
    v_pk_add_f32 v[106:107], v[106:107], v[138:139]
    v_cvt_pk_bf16_f32 v183, v106, v107
    ds_write_b64 v67, v[182:183]
    ds_read_b128 v[108:111], v69 offset:0
    ds_read_b128 v[112:115], v69 offset:1024
    ds_read_b128 v[116:119], v69 offset:2048
    ds_read_b128 v[120:123], v69 offset:3072
    s_waitcnt lgkmcnt(3)
    buffer_store_dwordx4 v[108:111], v70, s[32:35], 0 offen offset:0 sc1
    s_waitcnt lgkmcnt(2)
    buffer_store_dwordx4 v[112:115], v71, s[32:35], 0 offen offset:1024 sc1
    s_waitcnt lgkmcnt(1)
    buffer_store_dwordx4 v[116:119], v70, s[32:35], 0 offen offset:2048 sc1
    s_mov_b64 exec, 0xff
    s_waitcnt lgkmcnt(0)
    buffer_store_dwordx4 v[120:123], v71, s[32:35], 0 offen offset:3072 sc1
LM_fin:
LM_end:
    s_endpgm
.section .rodata,"a"
.p2align 6
.amdhsa_kernel egnn_sort_kernel
  .amdhsa_next_free_vgpr 120
  .amdhsa_next_free_sgpr 100
  .amdhsa_accum_offset 120
  .amdhsa_group_segment_fixed_size 0
  .amdhsa_kernarg_size 88
  .amdhsa_user_sgpr_count 2
  .amdhsa_user_sgpr_kernarg_segment_ptr 1
  .amdhsa_system_sgpr_workgroup_id_x 1
.end_amdhsa_kernel
.p2align 6
.amdhsa_kernel egnn_main_kernel
  .amdhsa_next_free_vgpr 256
  .amdhsa_next_free_sgpr 100
  .amdhsa_accum_offset 256
  .amdhsa_group_segment_fixed_size 0
  .amdhsa_kernarg_size 88
  .amdhsa_user_sgpr_count 2
  .amdhsa_user_sgpr_kernarg_segment_ptr 1
  .amdhsa_system_sgpr_workgroup_id_x 1
.end_amdhsa_kernel
```
